```python
import torch

def _softmax(x, axis=-1):
    return torch.softmax(x, dim=axis)
def _gelu(x):
    return torch.nn.functional.gelu(x, approximate="tanh")
def _silu(x):
    return torch.nn.functional.silu(x)
def _sigmoid(x):
    return torch.sigmoid(x)
def _layernorm(x, axis=-1, eps=1e-5):
    m = x.mean(dim=axis, keepdim=True)
    v = x.var(dim=axis, keepdim=True, unbiased=False)
    return (x - m) / torch.sqrt(v + eps)
def _scatter_add(tgt, idx, src, axis=0):
    return tgt.clone().index_add_(axis, idx, src)
def _segment_sum(src, seg, n):
    out = torch.zeros((n,) + src.shape[1:], dtype=src.dtype)
    return out.index_add_(0, seg, src)
def _pad(x, pw):
    flat = tuple(v for pair in reversed(pw) for v in pair)
    return torch.nn.functional.pad(x, flat)

kernel_name = 'gated_mix__grouped_kv_mqa__ssm_conv_s4__prompt'

def setup_inputs():

    _w = (lambda a: (lambda t: t.to(torch.bfloat16) if t.is_floating_point() else t)(torch.as_tensor(a)))
    def _A_setup():
        B, S, D, H = 1, 2048, 448, 16
        Dh = D // H
        return {
            "x": _w((lambda *s: torch.randn(*s, dtype=torch.bfloat16) * 0.05)(B, S, D)),
            "wq": _w((lambda *s: torch.randn(*s, dtype=torch.bfloat16) * 1.6)(D, H * Dh)),
            "wk": _w((lambda *s: torch.randn(*s, dtype=torch.bfloat16) * 1.6)(D, Dh)),
            "wv": _w((lambda *s: torch.randn(*s, dtype=torch.bfloat16) * 0.05)(D, Dh)),
            "wo": _w((lambda *s: torch.randn(*s, dtype=torch.bfloat16) * 0.05)(H * Dh, D)),
        }
    _A_in = _A_setup()

    def _B_setup():
        B, L, D, N = 1, 2048, 448, 256
        A_re = -(lambda _x: torch.exp(torch.as_tensor(_x)))((lambda *s: torch.randn(*s, dtype=torch.bfloat16) * 3.2)(D, N))
        A_im = torch.pi * (lambda *s: torch.randn(*s, dtype=torch.bfloat16) * 0.05)(D, N)
        B_re = (lambda *s: torch.randn(*s, dtype=torch.bfloat16) * 0.2)(D, N)
        B_im = (lambda *s: torch.randn(*s, dtype=torch.bfloat16) * 0.2)(D, N)
        C_re = (lambda *s: torch.randn(*s, dtype=torch.bfloat16) * 0.2)(D, N)
        C_im = (lambda *s: torch.randn(*s, dtype=torch.bfloat16) * 0.2)(D, N)
        log_dt = (lambda *s: torch.randn(*s, dtype=torch.bfloat16) * 0.05)(D) * 0.5 - 4.0
        Dskip = (lambda *s: torch.randn(*s, dtype=torch.bfloat16) * 0.1)(D)
        return {
            "u": _w((lambda *s: torch.randn(*s, dtype=torch.bfloat16) * 0.05)(B, L, D)),
            "A_re": _w(A_re),
            "A_im": _w(A_im),
            "B_re": _w(B_re),
            "B_im": _w(B_im),
            "C_re": _w(C_re),
            "C_im": _w(C_im),
            "log_dt": _w(log_dt),
            "Dskip": _w(Dskip),
        }
    _B_in = _B_setup()

    return {
        "A_x": _A_in["x"],
        "A_wq": _A_in["wq"],
        "A_wk": _A_in["wk"],
        "A_wv": _A_in["wv"],
        "A_wo": _A_in["wo"],
        "B_u": _B_in["u"],
        "B_A_re": _B_in["A_re"],
        "B_A_im": _B_in["A_im"],
        "B_B_re": _B_in["B_re"],
        "B_B_im": _B_in["B_im"],
        "B_C_re": _B_in["C_re"],
        "B_C_im": _B_in["C_im"],
        "B_log_dt": _B_in["log_dt"],
        "B_Dskip": _B_in["Dskip"],
        "gate_w": _w((lambda *s: torch.randn(*s, dtype=torch.bfloat16) * 0.05)(448) * 16.0),
    }

def reference(A_x, A_wq, A_wk, A_wv, A_wo, B_u, B_A_re, B_A_im, B_B_re, B_B_im, B_C_re, B_C_im, B_log_dt, B_Dskip, gate_w):
    def _A_ref(x, wq, wk, wv, wo):
        B, S, D = x.shape
        H = 16
        Dh = D // H
        q = (lambda x, *d: x.permute(*d))((x @ wq).reshape(B, S, H, Dh), 0, 2, 1, 3)
        k = x @ wk
        v = x @ wv
        scores = torch.einsum("bhqd,bkd->bhqk", q, k) * (Dh ** -0.5)
        p = _softmax(scores, axis=-1)
        o = torch.einsum("bhqk,bkd->bhqd", p, v)
        return (lambda x, *d: x.permute(*d))(o, 0, 2, 1, 3).reshape(B, S, H * Dh) @ wo

    def _B_ref(u, A_re, A_im, B_re, B_im, C_re, C_im, log_dt, Dskip):
        Bsz, L, D = u.shape
        dt = torch.exp(log_dt)[:, None]
        A = A_re + 1j * A_im
        Bc = B_re + 1j * B_im
        Cc = C_re + 1j * C_im
        logdA = dt * A
        dB = dt * Bc
        l = (lambda x, dt: x.to(dt))(torch.arange(L), A_re.dtype)
        P = torch.exp(logdA[:, :, None] * l[None, None, :])
        K = torch.einsum("dn,dnl,dn->dl", Cc, P, dB).real
        L2 = 2 * L
        Kp = _pad(K, ((0, 0), (0, L)))
        up = (lambda x, *d: x.permute(*d))(u, 0, 2, 1)
        up = _pad(up, ((0, 0), (0, 0), (0, L)))
        Kf = (lambda x, axes=(-2,-1): torch.fft.rfft2(x.float(), dim=axes))(Kp[:, None, :], axes=(-2, -1))
        Uf = (lambda x, axes=(-2,-1): torch.fft.rfft2(x.float(), dim=axes))(up[:, :, None, :], axes=(-2, -1))
        Yf = Uf * Kf[None, :, :, :]
        y = (lambda x, s, axes=(-2,-1): torch.fft.irfft2(x, s=s, dim=axes).to(torch.bfloat16))(Yf, (1, L2), axes=(-2, -1))[:, :, 0, :L]
        y = (lambda x, *d: x.permute(*d))(y, 0, 2, 1) + u * Dskip[None, None, :]
        return y

    x = A_x
    g = _sigmoid((x * gate_w).sum(-1, keepdims=True))
    a = _A_ref(x, A_wq, A_wk, A_wv, A_wo)
    b = _B_ref(x, B_A_re, B_A_im, B_B_re, B_B_im, B_C_re, B_C_im, B_log_dt, B_Dskip)
    return g * a + (1 - g) * b
```

```asm
; @launch grid=(512,1,1) block=(256,1,1) lds=81920
.amdgcn_target "amdgcn-amd-amdhsa--gfx950"
.text
.globl gated_mix__grouped_kv_mqa__ssm_conv_s4__prompt_kernel
.p2align 8
.type gated_mix__grouped_kv_mqa__ssm_conv_s4__prompt_kernel,@function
gated_mix__grouped_kv_mqa__ssm_conv_s4__prompt_kernel:
    s_cmp_ge_u32 s2, 512
    s_cbranch_scc1 L_end
    s_load_dwordx16 s[16:31], s[0:1], 0
    s_load_dwordx16 s[32:47], s[0:1], 64
    s_load_dwordx2 s[48:49], s[0:1], 136
    v_and_b32 v1, 63, v0
    v_lshrrev_b32 v2, 6, v0
    s_nop 0
    v_readfirstlane_b32 s3, v2
    s_cmp_ge_u32 s2, 256
    s_cbranch_scc1 L_roleA
L_roleS:
    s_setprio 3
    s_mov_b32 s8, s2
    s_lshr_b32 s9, s8, 3
    s_bfm_b32 s5, s9, 0
    s_bitcmp1_b32 0x552b552b, s9
    s_cselect_b32 s6, 0, -1
    s_cselect_b32 s7, 16, 0
    s_xor_b32 s6, s6, 0x552b552b
    s_and_b32 s5, s5, s6
    s_bcnt1_i32_b32 s5, s5
    s_add_u32 s9, s5, s7
    s_and_b32 s10, s8, 7
    s_mul_i32 s15, s10, 28
    s_add_u32 s15, s15, s9
    v_lshrrev_b32 v13, 2, v1
    v_mul_u32_u24 v2, 896, v13
    v_lshrrev_b32 v13, 4, v1
    v_xor_b32 v13, v13, v1
    v_and_b32 v13, 3, v13
    v_lshl_add_u32 v2, v13, 4, v2
    v_lshlrev_b32 v5, 4, v1
    s_lshl_b32 s10, s10, 3
    s_sub_u32 s5, s9, 16
    s_lshr_b32 s5, s5, 1
    s_add_u32 s11, s10, s5
    s_and_b32 s12, s9, 1
    s_lshl_b32 s5, s3, 13
    s_add_u32 s5, s5, 16896
    s_cmp_eq_u32 s3, 0
    s_cselect_b32 s13, 8192, s5
    s_mul_i32 s14, s3, 7232
    s_add_u32 s14, s14, 49664
    s_mul_i32 s5, s11, 28672
    s_lshl_b32 s6, s3, 8
    s_add_u32 s5, s5, s6
    s_add_u32 s6, s5, 14336
    s_mov_b32 m0, s13
    s_mov_b32 s62, 25088
    s_mov_b32 s63, 0x20000
    s_mov_b32 s54, 0x1c0000
    s_mov_b32 s55, 0x20000
    s_cmp_lt_u32 s9, 28
    s_cselect_b32 s7, s15, 0
    s_lshl_b32 s74, s7, 2
    s_cmp_lt_u32 s9, 16
    s_waitcnt lgkmcnt(0)
    s_load_dword s4, s[48:49], 12
    s_load_dword s72, s[40:41], s74
    s_load_dword s73, s[42:43], s74
    s_cbranch_scc1 L_s_nokv1
    s_mov_b32 s52, s16
    s_mov_b32 s53, s17
    s_cmp_eq_u32 s12, 0
    s_cselect_b32 s60, s20, s22
    s_cselect_b32 s61, s21, s23
    buffer_load_dwordx4 v2, s[52:55], s5 offen lds
    s_add_u32 m0, m0, 1024
    s_add_u32 s5, s5, 64
    buffer_load_dwordx4 v2, s[52:55], s6 offen lds
    s_add_u32 m0, m0, 1024
    s_add_u32 s6, s6, 64
    buffer_load_dwordx4 v2, s[52:55], s5 offen lds
    s_add_u32 m0, m0, 1024
    s_add_u32 s5, s5, 64
    buffer_load_dwordx4 v2, s[52:55], s6 offen lds
    s_add_u32 m0, m0, 1024
    s_add_u32 s6, s6, 64
    buffer_load_dwordx4 v2, s[52:55], s5 offen lds
    s_add_u32 m0, m0, 1024
    s_add_u32 s5, s5, 64
    buffer_load_dwordx4 v2, s[52:55], s6 offen lds
    s_add_u32 m0, m0, 1024
    s_add_u32 s6, s6, 64
    buffer_load_dwordx4 v2, s[52:55], s5 offen lds
    s_add_u32 m0, m0, 1024
    s_nop 0
    buffer_load_dwordx4 v2, s[52:55], s6 offen lds
    s_add_u32 m0, m0, 1024
    s_mul_i32 s5, s3, 7168
    s_mov_b32 m0, s14
    s_add_u32 s6, s5, 4096
    buffer_load_dwordx4 v5, s[60:63], s5 offen offset:0 lds
    buffer_load_dwordx4 v5, s[60:63], s5 offen offset:1024 lds
    buffer_load_dwordx4 v5, s[60:63], s5 offen offset:2048 lds
    buffer_load_dwordx4 v5, s[60:63], s5 offen offset:3072 lds
    s_add_u32 m0, m0, 4096
    s_nop 0
    buffer_load_dwordx4 v5, s[60:63], s6 offen offset:0 lds
    buffer_load_dwordx4 v5, s[60:63], s6 offen offset:1024 lds
    buffer_load_dwordx4 v5, s[60:63], s6 offen offset:2048 lds
L_s_nokv1:
    s_lshl_b32 s5, s7, 10
    s_lshl_b32 s6, s3, 8
    s_add_u32 s5, s5, s6
    v_lshlrev_b32 v7, 2, v1
    v_add_u32 v7, s5, v7
    global_load_dword v240, v7, s[28:29]
    global_load_dword v241, v7, s[30:31]
    global_load_dword v242, v7, s[32:33]
    global_load_dword v243, v7, s[34:35]
    global_load_dword v244, v7, s[36:37]
    global_load_dword v245, v7, s[38:39]
    s_mov_b32 s56, s48
    s_mov_b32 s57, s49
    s_mov_b32 s58, 0x1000000
    s_mov_b32 s59, 0x20000
    s_mov_b32 s64, s24
    s_mov_b32 s65, s25
    s_mov_b32 s66, 0x62000
    s_mov_b32 s67, 0x20000
    s_cmp_lt_u32 s9, 16
    s_cbranch_scc1 L_s_nokv2
    v_and_b32 v13, 31, v1
    v_lshlrev_b32 v3, 6, v13
    v_lshrrev_b32 v13, 2, v1
    v_lshrrev_b32 v14, 5, v1
    v_xor_b32 v13, v13, v14
    v_and_b32 v13, 3, v13
    v_lshl_add_u32 v3, v13, 4, v3
    v_xor_b32 v4, 32, v3
    v_lshrrev_b32 v13, 5, v1
    v_mul_u32_u24 v13, 8, v13
    v_bfe_u32 v14, v1, 2, 2
    v_add_u32 v13, v13, v14
    v_mul_u32_u24 v6, 56, v13
    v_and_b32 v13, 16, v1
    v_lshl_add_u32 v6, v13, 1, v6
    v_and_b32 v13, 3, v1
    v_lshl_add_u32 v6, v13, 3, v6
    v_add_u32 v6, s14, v6
    v_add_u32 v3, s13, v3
    v_add_u32 v4, s13, v4
    s_lshl_b32 s5, s3, 11
    v_add_u32 v8, s5, v5
    s_lshl_b32 s5, s12, 12
    s_add_u32 s5, s5, s13
    v_lshrrev_b32 v13, 5, v1
    v_lshlrev_b32 v20, 11, v13
    v_bfe_u32 v13, v1, 2, 2
    v_lshl_add_u32 v20, v13, 6, v20
    v_and_b32 v13, 1, v1
    v_lshl_add_u32 v20, v13, 3, v20
    v_add_u32 v20, s5, v20
    v_bfe_u32 v13, v1, 4, 1
    v_bfe_u32 v14, v1, 1, 1
    v_lshl_add_u32 v13, v13, 1, v14
    v_xor_b32 v14, 0, v13
    v_lshl_add_u32 v16, v14, 4, v20
    v_xor_b32 v14, 1, v13
    v_lshl_add_u32 v17, v14, 4, v20
    v_xor_b32 v14, 2, v13
    v_lshl_add_u32 v18, v14, 4, v20
    v_xor_b32 v14, 3, v13
    v_lshl_add_u32 v19, v14, 4, v20
    s_lshl_b32 s5, s3, 1
    s_add_u32 s5, s5, s12
    s_lshl_b32 s84, s5, 6
    s_add_u32 s84, s84, s11
    s_lshl_b32 s84, s84, 7
    s_add_u32 s84, s84, 0x7000c
    s_lshl_b32 s5, s5, 10
    s_mul_i32 s85, s11, 28672
    s_add_u32 s85, s85, s5
    s_add_u32 s85, s85, 0x600000
    s_cmp_eq_u32 s12, 0
    s_cselect_b32 s74, 0, 0xe0000000
    s_mov_b32 s75, s74
    s_mov_b32 s76, s74
    s_cselect_b32 s78, 0, 0x10000000
    s_mov_b32 s79, s78
    s_cselect_b32 s5, -1, 0
    s_cmp_eq_u32 s3, 1
    s_cselect_b32 s5, s5, 0
    s_or_b32 s77, s74, s5
    v_mov_b32 v9, 0x3f803f80
    v_cndmask_b32 v21, -1, 0, s[74:75]
    v_cndmask_b32 v22, -1, 0, s[76:77]
    v_cndmask_b32 v23, 0, v9, s[78:79]
    v_cndmask_b32 v21, v21, 0, s[78:79]
    v_cndmask_b32 v22, v22, 0, s[78:79]
    s_waitcnt vmcnt(6) lgkmcnt(0)
    s_add_u32 s4, s4, 0x9e3779b9
    ds_read_b128 v[64:67], v3 offset:0
    ds_read_b64_tr_b16 v[96:97], v6 offset:0
    ds_read_b64_tr_b16 v[98:99], v6 offset:224
    ds_read_b128 v[68:71], v4 offset:0
    ds_read_b64_tr_b16 v[100:101], v6 offset:896
    ds_read_b64_tr_b16 v[102:103], v6 offset:1120
    ds_read_b128 v[72:75], v3 offset:2048
    ds_read_b64_tr_b16 v[104:105], v6 offset:1792
    ds_read_b64_tr_b16 v[106:107], v6 offset:2016
    ds_read_b128 v[76:79], v4 offset:2048
    ds_read_b64_tr_b16 v[108:109], v6 offset:2688
    ds_read_b64_tr_b16 v[110:111], v6 offset:2912
    ds_read_b128 v[80:83], v3 offset:4096
    ds_read_b64_tr_b16 v[112:113], v6 offset:3584
    ds_read_b64_tr_b16 v[114:115], v6 offset:3808
    ds_read_b128 v[84:87], v4 offset:4096
    ds_read_b64_tr_b16 v[116:117], v6 offset:4480
    ds_read_b64_tr_b16 v[118:119], v6 offset:4704
    ds_read_b128 v[88:91], v3 offset:6144
    ds_read_b64_tr_b16 v[120:121], v6 offset:5376
    ds_read_b64_tr_b16 v[122:123], v6 offset:5600
    ds_read_b128 v[92:95], v4 offset:6144
    ds_read_b64_tr_b16 v[124:125], v6 offset:6272
    ds_read_b64_tr_b16 v[126:127], v6 offset:6496
    s_cmp_eq_u32 s12, 0
    s_cbranch_scc0 L_s_kind1
    s_waitcnt lgkmcnt(15)
    v_mfma_f32_32x32x16_bf16 v[48:63], v[96:99], v[64:67], 0
    s_waitcnt lgkmcnt(15)
    v_mfma_f32_32x32x16_bf16 v[48:63], v[100:103], v[68:71], v[48:63]
    s_waitcnt lgkmcnt(15)
    v_mfma_f32_32x32x16_bf16 v[48:63], v[104:107], v[72:75], v[48:63]
    ds_read_b64_tr_b16 v[128:129], v16 offset:0
    ds_read_b64_tr_b16 v[130:131], v17 offset:256
    s_waitcnt lgkmcnt(14)
    v_mfma_f32_32x32x16_bf16 v[48:63], v[108:111], v[76:79], v[48:63]
    ds_read_b64_tr_b16 v[132:133], v18 offset:512
    ds_read_b64_tr_b16 v[134:135], v19 offset:768
    s_waitcnt lgkmcnt(13)
    v_mfma_f32_32x32x16_bf16 v[48:63], v[112:115], v[80:83], v[48:63]
    ds_read_b64_tr_b16 v[136:137], v16 offset:1024
    ds_read_b64_tr_b16 v[138:139], v17 offset:1280
    s_waitcnt lgkmcnt(12)
    v_mfma_f32_32x32x16_bf16 v[48:63], v[116:119], v[84:87], v[48:63]
    ds_read_b64_tr_b16 v[140:141], v18 offset:1536
    ds_read_b64_tr_b16 v[142:143], v19 offset:1792
    s_waitcnt lgkmcnt(11)
    v_mfma_f32_32x32x16_bf16 v[48:63], v[120:123], v[88:91], v[48:63]
    s_waitcnt lgkmcnt(8)
    v_mfma_f32_32x32x16_bf16 v[48:63], v[124:127], v[92:95], v[48:63]
    s_branch L_s_kindj
L_s_kind1:
    s_waitcnt lgkmcnt(15)
    v_mfma_f32_32x32x16_bf16 v[48:63], v[64:67], v[96:99], 0
    s_waitcnt lgkmcnt(15)
    v_mfma_f32_32x32x16_bf16 v[48:63], v[68:71], v[100:103], v[48:63]
    s_waitcnt lgkmcnt(15)
    v_mfma_f32_32x32x16_bf16 v[48:63], v[72:75], v[104:107], v[48:63]
    ds_read_b64_tr_b16 v[128:129], v16 offset:0
    ds_read_b64_tr_b16 v[130:131], v17 offset:256
    s_waitcnt lgkmcnt(14)
    v_mfma_f32_32x32x16_bf16 v[48:63], v[76:79], v[108:111], v[48:63]
    ds_read_b64_tr_b16 v[132:133], v18 offset:512
    ds_read_b64_tr_b16 v[134:135], v19 offset:768
    s_waitcnt lgkmcnt(13)
    v_mfma_f32_32x32x16_bf16 v[48:63], v[80:83], v[112:115], v[48:63]
    ds_read_b64_tr_b16 v[136:137], v16 offset:1024
    ds_read_b64_tr_b16 v[138:139], v17 offset:1280
    s_waitcnt lgkmcnt(12)
    v_mfma_f32_32x32x16_bf16 v[48:63], v[84:87], v[116:119], v[48:63]
    ds_read_b64_tr_b16 v[140:141], v18 offset:1536
    ds_read_b64_tr_b16 v[142:143], v19 offset:1792
    s_waitcnt lgkmcnt(11)
    v_mfma_f32_32x32x16_bf16 v[48:63], v[88:91], v[120:123], v[48:63]
    s_waitcnt lgkmcnt(8)
    v_mfma_f32_32x32x16_bf16 v[48:63], v[92:95], v[124:127], v[48:63]
L_s_kindj:
    s_nop 11
    ds_write_b128 v8, v[48:51] offset:0
    ds_write_b128 v8, v[52:55] offset:1024
    ds_write_b128 v8, v[56:59] offset:16896
    ds_write_b128 v8, v[60:63] offset:17920
    s_waitcnt lgkmcnt(0)
    s_barrier
    s_cmp_ge_u32 s3, 2
    s_cbranch_scc1 L_s_kvdone
    s_mul_i32 s5, s3, 16896
    v_add_u32 v8, s5, v5
    ds_read_b128 v[64:67], v8 offset:0
    ds_read_b128 v[68:71], v8 offset:1024
    ds_read_b128 v[72:75], v8 offset:2048
    ds_read_b128 v[76:79], v8 offset:3072
    ds_read_b128 v[80:83], v8 offset:4096
    ds_read_b128 v[84:87], v8 offset:5120
    ds_read_b128 v[88:91], v8 offset:6144
    ds_read_b128 v[92:95], v8 offset:7168
    s_lshl_b32 s5, s11, 1
    s_add_u32 s5, s5, s12
    s_lshl_b32 s5, s5, 1
    s_add_u32 s5, s5, s3
    s_lshl_b32 s6, s5, 10
    s_add_u32 s6, s6, 0x100000
    s_lshl_b32 s7, s5, 7
    s_add_u32 s7, s7, 0x100c
    s_waitcnt lgkmcnt(4)
    v_pk_add_f32 v[64:65], v[64:65], v[72:73]
    v_pk_add_f32 v[66:67], v[66:67], v[74:75]
    v_pk_add_f32 v[68:69], v[68:69], v[76:77]
    v_pk_add_f32 v[70:71], v[70:71], v[78:79]
    s_waitcnt lgkmcnt(0)
    v_pk_add_f32 v[80:81], v[80:81], v[88:89]
    v_pk_add_f32 v[82:83], v[82:83], v[90:91]
    v_pk_add_f32 v[84:85], v[84:85], v[92:93]
    v_pk_add_f32 v[86:87], v[86:87], v[94:95]
    v_pk_add_f32 v[64:65], v[64:65], v[80:81]
    v_pk_add_f32 v[66:67], v[66:67], v[82:83]
    v_pk_add_f32 v[68:69], v[68:69], v[84:85]
    v_pk_add_f32 v[70:71], v[70:71], v[86:87]
    v_cvt_pk_bf16_f32 v72, v64, v65
    v_cvt_pk_bf16_f32 v73, v66, v67
    v_cvt_pk_bf16_f32 v74, v68, v69
    v_cvt_pk_bf16_f32 v75, v70, v71
    v_and_or_b32 v72, v72, v21, v23
    v_and_or_b32 v73, v73, v21, v23
    v_and_or_b32 v74, v74, v22, v23
    v_and_or_b32 v75, v75, v22, v23
    buffer_store_dwordx4 v[72:75], v5, s[56:59], s6 offen sc1
    s_waitcnt vmcnt(0)
    v_mov_b32 v9, s4
    s_mov_b32 exec_lo, 1
    s_mov_b32 exec_hi, 0
    buffer_store_dword v9, off, s[56:59], s7 sc1
    s_mov_b64 exec, -1
L_s_kvdone:
    s_setprio 2
    s_waitcnt vmcnt(0)
    s_cmp_ge_u32 s84, 0x7e00c
    s_cbranch_scc1 L_s_noxt
    buffer_store_dwordx4 v[128:131], v5, s[56:59], s85 offen sc1
    s_add_u32 s85, s85, 7168
    buffer_store_dwordx4 v[132:135], v5, s[56:59], s85 offen sc1
    s_add_u32 s85, s85, 7168
    buffer_store_dwordx4 v[136:139], v5, s[56:59], s85 offen sc1
    s_add_u32 s85, s85, 7168
    buffer_store_dwordx4 v[140:143], v5, s[56:59], s85 offen sc1
L_s_noxt:
    s_mov_b32 s82, 0
    s_cmp_lt_u32 s9, 28
    s_cbranch_scc1 L_s_kgen
    s_cmp_lg_u32 s3, 3
    s_cbranch_scc1 L_s_ali
    s_lshl_b32 s5, s2, 7
    s_add_u32 s5, s5, 0x5000c
    v_mov_b32 v13, s4
    s_mov_b32 exec_lo, 1
    s_mov_b32 exec_hi, 0
    buffer_store_dword v13, off, s[56:59], s5 sc1
    s_mov_b64 exec, -1
L_s_ali:
    s_lshr_b32 s5, s9, 2
    s_mov_b32 s6, 0x1201000
    s_cmp_eq_u32 s5, 1
    s_cselect_b32 s6, 0x12022111, s6
    s_cmp_eq_u32 s5, 2
    s_cselect_b32 s6, 0x23130322, s6
    s_cmp_eq_u32 s5, 3
    s_cselect_b32 s6, 0x25052414, s6
    s_cmp_eq_u32 s5, 4
    s_cselect_b32 s6, 0x33323130, s6
    s_cmp_eq_u32 s5, 5
    s_cselect_b32 s6, 0x6363534, s6
    s_cmp_eq_u32 s5, 6
    s_cselect_b32 s6, 0x27170716, s6
    s_cmp_eq_u32 s5, 7
    s_cselect_b32 s6, 0x37261504, s6
    s_and_b32 s5, s9, 3
    s_lshl_b32 s5, s5, 3
    s_lshr_b32 s6, s6, s5
    s_and_b32 s5, s6, 7
    s_add_u32 s11, s10, s5
    s_bfe_u32 s12, s6, 0x20004
    s_cmp_eq_u32 s12, 3
    s_cselect_b32 s5, 1, 3
    s_and_b32 s85, s3, s5
    s_lshl_b32 s5, s12, 2
    s_add_u32 s5, s5, s85
    s_lshl_b32 s86, s5, 10
    s_add_u32 s86, s86, 0xb000c
    s_lshl_b32 s5, s5, 15
    s_add_u32 s5, s5, 0xc00000
    s_add_u32 s88, s48, s5
    s_addc_u32 s89, s49, 0
    s_mov_b32 s90, 0x8000
    s_mov_b32 s91, 0x20000
    s_cmp_lg_u32 s3, s85
    s_cbranch_scc1 L_s_nodma
    v_lshrrev_b32 v13, 2, v1
    v_mul_u32_u24 v8, 896, v13
    v_and_b32 v13, 3, v1
    v_lshl_add_u32 v8, v13, 4, v8
    s_mul_i32 s5, s10, 6272
    s_lshl_b32 s6, s12, 8
    s_add_u32 s5, s5, s6
    s_lshl_b32 s6, s3, 6
    s_add_u32 s5, s5, s6
    s_mov_b32 m0, s13
    s_nop 0
    buffer_load_dwordx4 v8, s[64:67], s5 offen lds
    s_add_u32 m0, m0, 1024
    s_add_u32 s5, s5, 14336
    buffer_load_dwordx4 v8, s[64:67], s5 offen lds
    s_add_u32 m0, m0, 1024
    s_add_u32 s5, s5, 10752
    buffer_load_dwordx4 v8, s[64:67], s5 offen lds
    s_add_u32 m0, m0, 1024
    s_add_u32 s5, s5, 14336
    buffer_load_dwordx4 v8, s[64:67], s5 offen lds
L_s_nodma:
    v_bfe_u32 v13, v1, 4, 1
    v_and_b32 v14, 3, v1
    v_lshl_add_u32 v13, v13, 2, v14
    v_lshlrev_b32 v13, 3, v13
    v_add_u32 v13, s13, v13
    v_bfe_u32 v14, v1, 2, 2
    v_lshl_add_u32 v16, v14, 6, v13
    v_lshrrev_b32 v15, 5, v1
    v_lshl_add_u32 v9, v15, 8, v16
    v_lshlrev_b32 v15, 3, v14
    s_mov_b32 s5, 0x1b1b0f0b
    v_lshrrev_b32 v15, v15, s5
    v_and_b32 v15, 0xff, v15
    v_lshl_add_u32 v13, v15, 6, v13
    v_add_u32 v10, 1536, v9
    s_mov_b32 s72, 0
    s_mov_b32 s73, -1
    v_cndmask_b32 v10, v10, v13, s[72:73]
    s_cmp_ge_u32 s84, 0x7e00c
    s_cbranch_scc1 L_s_noxfa
    s_waitcnt vmcnt(0)
    v_mov_b32 v14, s4
    s_mov_b32 exec_lo, 1
    s_mov_b32 exec_hi, 0
    buffer_store_dword v14, off, s[56:59], s84 sc1
    s_mov_b64 exec, -1
L_s_noxfa:
    s_cmp_lg_u32 s3, 2
    s_cbranch_scc1 L_s_noag
    s_sub_u32 s13, s9, 28
    s_lshl_b32 s5, s13, 13
    s_add_u32 s5, s5, 0x100c
    v_lshlrev_b32 v13, 7, v1
    v_add_u32 v13, s5, v13
    s_lshr_b32 s14, s10, 1
    s_add_u32 s14, s14, s13
    s_lshl_b32 s14, s14, 7
    s_add_u32 s14, s14, 0xa000c
    s_mov_b32 s5, 0
L_poll_ag:
    buffer_load_dword v14, v13, s[56:59], 0 offen sc1
    s_waitcnt vmcnt(0)
    v_cmp_ne_u32 vcc, s4, v14
    s_nop 1
    s_cmp_eq_u64 vcc, 0
    s_cbranch_scc1 L_pollok_ag
    s_mov_b64 exec, vcc
    s_add_u32 s5, s5, 1
    s_cmp_lt_u32 s5, 400000
    s_cbranch_scc1 L_poll_ag
L_pollok_ag:
    s_mov_b64 exec, -1
    v_mov_b32 v13, s4
    s_mov_b32 exec_lo, 1
    s_mov_b32 exec_hi, 0
    buffer_store_dword v13, off, s[56:59], s14
    s_mov_b64 exec, -1
    s_add_u32 s14, s14, 0x8000
    v_mov_b32 v13, s4
    s_mov_b32 exec_lo, 1
    s_mov_b32 exec_hi, 0
    buffer_store_dword v13, off, s[56:59], s14 sc1
    s_mov_b64 exec, -1
L_s_noag:
    s_cmp_lg_u32 s3, s85
    s_cbranch_scc1 L_s_nostage
    s_waitcnt vmcnt(0)
    ds_read_b64_tr_b16 v[128:129], v9 offset:0
    ds_read_b64_tr_b16 v[130:131], v9 offset:512
    ds_read_b64_tr_b16 v[132:133], v9 offset:1024
    ds_read_b64_tr_b16 v[134:135], v10 offset:0
    ds_read_b64_tr_b16 v[136:137], v9 offset:2048
    ds_read_b64_tr_b16 v[138:139], v9 offset:2560
    ds_read_b64_tr_b16 v[140:141], v9 offset:3072
    ds_read_b64_tr_b16 v[142:143], v10 offset:2048
    s_lshl_b32 s6, s10, 9
    s_lshl_b32 s7, s10, 4
    s_add_u32 s7, s7, s86
    s_waitcnt lgkmcnt(0)
    v_and_b32 v131, 0xffff, v131
    v_and_b32 v135, 0xffff, v135
    v_and_b32 v139, 0xffff, v139
    v_and_b32 v143, 0xffff, v143
    buffer_store_dwordx4 v[128:131], v5, s[88:91], s6 offen offset:0 sc1
    buffer_store_dwordx4 v[132:135], v5, s[88:91], s6 offen offset:1024 sc1
    buffer_store_dwordx4 v[136:139], v5, s[88:91], s6 offen offset:2048 sc1
    buffer_store_dwordx4 v[140:143], v5, s[88:91], s6 offen offset:3072 sc1
    s_waitcnt vmcnt(0)
    v_mov_b32 v13, s4
    s_mov_b32 exec_lo, 1
    s_mov_b32 exec_hi, 0
    buffer_store_dword v13, off, s[56:59], s7 sc1
    s_mov_b64 exec, -1
    s_barrier
    s_branch L_s_wfb
L_s_nostage:
    s_waitcnt lgkmcnt(0)
    s_barrier
    s_add_u32 s5, s10, s3
    s_cmp_lg_u32 s5, 59
    s_cbranch_scc1 L_s_wo
    v_lshlrev_b32 v21, 7, v1
    v_add_u32 v21, 0x5000c, v21
    s_mov_b32 s5, 0
L_poll_alive:
    buffer_load_dword v40, v21, s[56:59], 0 offen sc1
    s_mov_b32 s6, 0x2000
    buffer_load_dword v41, v21, s[56:59], s6 offen sc1
    s_mov_b32 s6, 0x4000
    buffer_load_dword v42, v21, s[56:59], s6 offen sc1
    s_mov_b32 s6, 0x6000
    buffer_load_dword v43, v21, s[56:59], s6 offen sc1
    s_mov_b32 s6, 0x8000
    buffer_load_dword v44, v21, s[56:59], s6 offen sc1
    s_mov_b32 s6, 0xa000
    buffer_load_dword v45, v21, s[56:59], s6 offen sc1
    s_mov_b32 s6, 0xc000
    buffer_load_dword v46, v21, s[56:59], s6 offen sc1
    s_mov_b32 s6, 0xe000
    buffer_load_dword v47, v21, s[56:59], s6 offen sc1
    s_waitcnt vmcnt(0)
    v_cmp_ne_u32 vcc, s4, v40
    v_cmp_ne_u32 s[6:7], s4, v41
    s_nop 1
    s_or_b64 vcc, vcc, s[6:7]
    v_cmp_ne_u32 s[6:7], s4, v42
    s_nop 1
    s_or_b64 vcc, vcc, s[6:7]
    v_cmp_ne_u32 s[6:7], s4, v43
    s_nop 1
    s_or_b64 vcc, vcc, s[6:7]
    v_cmp_ne_u32 s[6:7], s4, v44
    s_nop 1
    s_or_b64 vcc, vcc, s[6:7]
    v_cmp_ne_u32 s[6:7], s4, v45
    s_nop 1
    s_or_b64 vcc, vcc, s[6:7]
    v_cmp_ne_u32 s[6:7], s4, v46
    s_nop 1
    s_or_b64 vcc, vcc, s[6:7]
    v_cmp_ne_u32 s[6:7], s4, v47
    s_nop 1
    s_or_b64 vcc, vcc, s[6:7]
    s_cmp_eq_u64 vcc, 0
    s_cbranch_scc1 L_pollok_alive
    s_sleep 8
    s_add_u32 s5, s5, 1
    s_cmp_lt_u32 s5, 400000
    s_cbranch_scc1 L_poll_alive
L_pollok_alive:
    s_mov_b32 s5, 12
    v_mov_b32 v21, s4
    s_mov_b32 exec_lo, 1
    s_mov_b32 exec_hi, 0
    buffer_store_dword v21, off, s[56:59], s5 sc1
    s_mov_b64 exec, -1
    s_branch L_s_wo
L_s_nokv2:
    s_setprio 2
    s_mov_b32 s84, -1
    s_mov_b32 s82, 0
    s_waitcnt vmcnt(0) lgkmcnt(0)
    s_add_u32 s4, s4, 0x9e3779b9
L_s_kgen:
    s_cmp_lg_u32 s3, 3
    s_cbranch_scc1 L_s_alk
    s_lshl_b32 s5, s2, 7
    s_add_u32 s5, s5, 0x5000c
    v_mov_b32 v13, s4
    s_mov_b32 exec_lo, 1
    s_mov_b32 exec_hi, 0
    buffer_store_dword v13, off, s[56:59], s5 sc1
    s_mov_b64 exec, -1
L_s_alk:
    s_lshr_b32 s5, s9, 2
    s_mov_b32 s6, 0x1201000
    s_cmp_eq_u32 s5, 1
    s_cselect_b32 s6, 0x12022111, s6
    s_cmp_eq_u32 s5, 2
    s_cselect_b32 s6, 0x23130322, s6
    s_cmp_eq_u32 s5, 3
    s_cselect_b32 s6, 0x25052414, s6
    s_cmp_eq_u32 s5, 4
    s_cselect_b32 s6, 0x33323130, s6
    s_cmp_eq_u32 s5, 5
    s_cselect_b32 s6, 0x6363534, s6
    s_cmp_eq_u32 s5, 6
    s_cselect_b32 s6, 0x27170716, s6
    s_cmp_eq_u32 s5, 7
    s_cselect_b32 s6, 0x37261504, s6
    s_and_b32 s5, s9, 3
    s_lshl_b32 s5, s5, 3
    s_lshr_b32 s6, s6, s5
    s_and_b32 s5, s6, 7
    s_add_u32 s11, s10, s5
    s_bfe_u32 s12, s6, 0x20004
    s_cmp_eq_u32 s12, 3
    s_cselect_b32 s5, 1, 3
    s_and_b32 s85, s3, s5
    s_lshl_b32 s5, s12, 2
    s_add_u32 s5, s5, s85
    s_lshl_b32 s86, s5, 10
    s_add_u32 s86, s86, 0xb000c
    s_lshl_b32 s5, s5, 15
    s_add_u32 s5, s5, 0xc00000
    s_add_u32 s88, s48, s5
    s_addc_u32 s89, s49, 0
    s_mov_b32 s90, 0x8000
    s_mov_b32 s91, 0x20000
    s_lshr_b32 s5, s3, 1
    s_lshl_b32 s5, s5, 4
    s_lshr_b32 s72, s72, s5
    s_lshl_b32 s72, s72, 16
    s_lshr_b32 s73, s73, s5
    s_lshl_b32 s73, s73, 16
    v_mov_b32 v8, s72
    v_mul_f32 v9, 0x3fb8aa00, v8
    v_exp_f32 v9, v9
    v_mul_f32 v8, 0x36a407db, v8
    v_fma_f32 v9, v9, v8, v9
    v_cvt_pk_bf16_f32 v9, v9, v9
    v_and_b32 v9, 0xffff0000, v9
    v_lshlrev_b32 v16, 16, v240
    v_lshlrev_b32 v18, 16, v241
    v_and_b32 v17, 0xffff0000, v240
    v_and_b32 v19, 0xffff0000, v241
    v_mul_f32 v16, v9, v16
    v_mul_f32 v18, v9, v18
    v_mul_f32 v17, v9, v17
    v_mul_f32 v19, v9, v19
    v_mul_f32 v16, 0x3fb8aa3b, v16
    v_mul_f32 v18, 0x3e22f983, v18
    v_mul_f32 v17, 0x3fb8aa3b, v17
    v_mul_f32 v19, 0x3e22f983, v19
    v_mul_f32 v36, 0x41000000, v16
    v_mul_f32 v37, 0x41000000, v18
    v_fract_f32 v37, v37
    v_mul_f32 v38, 0x41000000, v17
    v_mul_f32 v39, 0x41000000, v19
    v_fract_f32 v39, v39
    v_exp_f32 v36, v36
    v_cos_f32 v24, v37
    v_sin_f32 v25, v37
    v_exp_f32 v38, v38
    v_cos_f32 v26, v39
    v_sin_f32 v27, v39
    v_pk_mul_f32 v[24:25], v[24:25], v[36:37] op_sel_hi:[1,0] neg_hi:[1,0]
    v_pk_mul_f32 v[26:27], v[26:27], v[38:39] op_sel_hi:[1,0] neg_hi:[1,0]
    s_mul_i32 s13, s3, 16896
    v_lshlrev_b32 v8, 3, v1
    v_add_u32 v8, s13, v8
    v_and_b32 v11, 31, v1
    v_mul_u32_u24 v11, 528, v11
    v_lshrrev_b32 v12, 5, v1
    v_lshl_add_u32 v11, v12, 4, v11
    v_add_u32 v11, s13, v11
    v_mov_b32 v56, 0x3f80
    v_mov_b32 v57, 0x3f80
    ds_write_b64 v8, v[56:57]
    v_cvt_pk_bf16_f32 v58, v24, v25
    v_cvt_pk_bf16_f32 v59, v26, v27
    ds_write_b64 v8, v[58:59] offset:528
    v_pk_mul_f32 v[36:37], v[24:25], v[24:25] op_sel_hi:[1,0]
    v_pk_mul_f32 v[38:39], v[26:27], v[26:27] op_sel_hi:[1,0]
    v_pk_fma_f32 v[40:41], v[24:25], v[24:25], v[36:37] op_sel:[1,1,0] op_sel_hi:[0,1,1] neg_lo:[1,0,0]
    v_pk_fma_f32 v[42:43], v[26:27], v[26:27], v[38:39] op_sel:[1,1,0] op_sel_hi:[0,1,1] neg_lo:[1,0,0]
    v_cvt_pk_bf16_f32 v60, v40, v41
    v_cvt_pk_bf16_f32 v61, v42, v43
    ds_write_b64 v8, v[60:61] offset:1056
    v_pk_mul_f32 v[36:37], v[40:41], v[24:25] op_sel_hi:[1,0]
    v_pk_mul_f32 v[38:39], v[42:43], v[26:27] op_sel_hi:[1,0]
    v_pk_fma_f32 v[40:41], v[40:41], v[24:25], v[36:37] op_sel:[1,1,0] op_sel_hi:[0,1,1] neg_lo:[1,0,0]
    v_pk_fma_f32 v[42:43], v[42:43], v[26:27], v[38:39] op_sel:[1,1,0] op_sel_hi:[0,1,1] neg_lo:[1,0,0]
    v_cvt_pk_bf16_f32 v62, v40, v41
    v_cvt_pk_bf16_f32 v63, v42, v43
    ds_write_b64 v8, v[62:63] offset:1584
    s_mov_b32 s7, 0
L_s_kl:
    v_pk_mul_f32 v[36:37], v[40:41], v[24:25] op_sel_hi:[1,0]
    v_pk_mul_f32 v[38:39], v[42:43], v[26:27] op_sel_hi:[1,0]
    v_pk_fma_f32 v[40:41], v[40:41], v[24:25], v[36:37] op_sel:[1,1,0] op_sel_hi:[0,1,1] neg_lo:[1,0,0]
    v_pk_fma_f32 v[42:43], v[42:43], v[26:27], v[38:39] op_sel:[1,1,0] op_sel_hi:[0,1,1] neg_lo:[1,0,0]
    v_cvt_pk_bf16_f32 v56, v40, v41
    v_cvt_pk_bf16_f32 v57, v42, v43
    ds_write_b64 v8, v[56:57] offset:2112
    v_pk_mul_f32 v[36:37], v[40:41], v[24:25] op_sel_hi:[1,0]
    v_pk_mul_f32 v[38:39], v[42:43], v[26:27] op_sel_hi:[1,0]
    v_pk_fma_f32 v[40:41], v[40:41], v[24:25], v[36:37] op_sel:[1,1,0] op_sel_hi:[0,1,1] neg_lo:[1,0,0]
    v_pk_fma_f32 v[42:43], v[42:43], v[26:27], v[38:39] op_sel:[1,1,0] op_sel_hi:[0,1,1] neg_lo:[1,0,0]
    v_cvt_pk_bf16_f32 v58, v40, v41
    v_cvt_pk_bf16_f32 v59, v42, v43
    ds_write_b64 v8, v[58:59] offset:2640
    v_pk_mul_f32 v[36:37], v[40:41], v[24:25] op_sel_hi:[1,0]
    v_pk_mul_f32 v[38:39], v[42:43], v[26:27] op_sel_hi:[1,0]
    v_pk_fma_f32 v[40:41], v[40:41], v[24:25], v[36:37] op_sel:[1,1,0] op_sel_hi:[0,1,1] neg_lo:[1,0,0]
    v_pk_fma_f32 v[42:43], v[42:43], v[26:27], v[38:39] op_sel:[1,1,0] op_sel_hi:[0,1,1] neg_lo:[1,0,0]
    v_cvt_pk_bf16_f32 v60, v40, v41
    v_cvt_pk_bf16_f32 v61, v42, v43
    ds_write_b64 v8, v[60:61] offset:3168
    v_pk_mul_f32 v[36:37], v[40:41], v[24:25] op_sel_hi:[1,0]
    v_pk_mul_f32 v[38:39], v[42:43], v[26:27] op_sel_hi:[1,0]
    v_pk_fma_f32 v[40:41], v[40:41], v[24:25], v[36:37] op_sel:[1,1,0] op_sel_hi:[0,1,1] neg_lo:[1,0,0]
    v_pk_fma_f32 v[42:43], v[42:43], v[26:27], v[38:39] op_sel:[1,1,0] op_sel_hi:[0,1,1] neg_lo:[1,0,0]
    v_cvt_pk_bf16_f32 v62, v40, v41
    v_cvt_pk_bf16_f32 v63, v42, v43
    ds_write_b64 v8, v[62:63] offset:3696
    v_add_u32 v8, 2112, v8
    s_cmp_lg_u32 s7, 2
    s_cbranch_scc1 L_s_kl1
    s_cmp_ge_u32 s84, 0x7e00c
    s_cbranch_scc1 L_s_noxfb
    s_waitcnt vmcnt(0)
    v_mov_b32 v14, s4
    s_mov_b32 exec_lo, 1
    s_mov_b32 exec_hi, 0
    buffer_store_dword v14, off, s[56:59], s84 sc1
    s_mov_b64 exec, -1
L_s_noxfb:
L_s_kl1:
    s_add_u32 s7, s7, 1
    s_cmp_lt_u32 s7, 7
    s_cbranch_scc1 L_s_kl
    v_subrev_u32 v8, 14784, v8
    ds_read_b128 v[64:67], v11 offset:0
    ds_read_b128 v[68:71], v11 offset:32
    ds_read_b128 v[72:75], v11 offset:64
    ds_read_b128 v[76:79], v11 offset:96
    ds_read_b128 v[80:83], v11 offset:128
    ds_read_b128 v[84:87], v11 offset:160
    ds_read_b128 v[88:91], v11 offset:192
    ds_read_b128 v[92:95], v11 offset:224
    ds_read_b128 v[96:99], v11 offset:256
    ds_read_b128 v[100:103], v11 offset:288
    ds_read_b128 v[104:107], v11 offset:320
    ds_read_b128 v[108:111], v11 offset:352
    ds_read_b128 v[112:115], v11 offset:384
    ds_read_b128 v[116:119], v11 offset:416
    ds_read_b128 v[120:123], v11 offset:448
    ds_read_b128 v[124:127], v11 offset:480
    v_mov_b32 v36, v16
    v_fract_f32 v37, v18
    v_mov_b32 v38, v17
    v_fract_f32 v39, v19
    v_exp_f32 v36, v36
    v_cos_f32 v20, v37
    v_sin_f32 v21, v37
    v_exp_f32 v38, v38
    v_cos_f32 v22, v39
    v_sin_f32 v23, v39
    v_pk_mul_f32 v[20:21], v[20:21], v[36:37] op_sel_hi:[1,0]
    v_pk_mul_f32 v[22:23], v[22:23], v[38:39] op_sel_hi:[1,0]
    v_mul_f32 v36, 0x43800000, v16
    v_mul_f32 v37, 0x43800000, v18
    v_fract_f32 v37, v37
    v_mul_f32 v38, 0x43800000, v17
    v_mul_f32 v39, 0x43800000, v19
    v_fract_f32 v39, v39
    v_exp_f32 v36, v36
    v_cos_f32 v28, v37
    v_sin_f32 v29, v37
    v_exp_f32 v38, v38
    v_cos_f32 v30, v39
    v_sin_f32 v31, v39
    v_pk_mul_f32 v[28:29], v[28:29], v[36:37] op_sel_hi:[1,0]
    v_pk_mul_f32 v[30:31], v[30:31], v[38:39] op_sel_hi:[1,0]
    v_lshlrev_b32 v40, 16, v242
    v_lshlrev_b32 v41, 16, v243
    v_lshlrev_b32 v44, 16, v244
    v_lshlrev_b32 v45, 16, v245
    v_and_b32 v42, 0xffff0000, v242
    v_and_b32 v43, 0xffff0000, v243
    v_and_b32 v46, 0xffff0000, v244
    v_and_b32 v47, 0xffff0000, v245
    v_mul_f32 v40, v9, v40
    v_mul_f32 v41, v9, v41
    v_mul_f32 v42, v9, v42
    v_mul_f32 v43, v9, v43
    v_pk_mul_f32 v[36:37], v[44:45], v[40:41] op_sel_hi:[1,0]
    v_pk_mul_f32 v[38:39], v[46:47], v[42:43] op_sel_hi:[1,0]
    v_pk_fma_f32 v[32:33], v[44:45], v[40:41], v[36:37] op_sel:[1,1,0] op_sel_hi:[0,1,1] neg_lo:[1,0,0]
    v_pk_fma_f32 v[34:35], v[46:47], v[42:43], v[38:39] op_sel:[1,1,0] op_sel_hi:[0,1,1] neg_lo:[1,0,0]
    v_cvt_pk_bf16_f32 v56, v32, v33
    v_cvt_pk_bf16_f32 v57, v34, v35
    ds_write_b64 v8, v[56:57] offset:0
    v_pk_mul_f32 v[36:37], v[32:33], v[20:21] op_sel_hi:[1,0]
    v_pk_mul_f32 v[38:39], v[34:35], v[22:23] op_sel_hi:[1,0]
    v_pk_fma_f32 v[40:41], v[32:33], v[20:21], v[36:37] op_sel:[1,1,0] op_sel_hi:[0,1,1] neg_lo:[1,0,0]
    v_pk_fma_f32 v[42:43], v[34:35], v[22:23], v[38:39] op_sel:[1,1,0] op_sel_hi:[0,1,1] neg_lo:[1,0,0]
    v_cvt_pk_bf16_f32 v58, v40, v41
    v_cvt_pk_bf16_f32 v59, v42, v43
    ds_write_b64 v8, v[58:59] offset:528
    v_pk_mul_f32 v[36:37], v[40:41], v[20:21] op_sel_hi:[1,0]
    v_pk_mul_f32 v[38:39], v[42:43], v[22:23] op_sel_hi:[1,0]
    v_pk_fma_f32 v[44:45], v[40:41], v[20:21], v[36:37] op_sel:[1,1,0] op_sel_hi:[0,1,1] neg_lo:[1,0,0]
    v_pk_fma_f32 v[46:47], v[42:43], v[22:23], v[38:39] op_sel:[1,1,0] op_sel_hi:[0,1,1] neg_lo:[1,0,0]
    v_cvt_pk_bf16_f32 v60, v44, v45
    v_cvt_pk_bf16_f32 v61, v46, v47
    ds_write_b64 v8, v[60:61] offset:1056
    v_pk_mul_f32 v[36:37], v[44:45], v[20:21] op_sel_hi:[1,0]
    v_pk_mul_f32 v[38:39], v[46:47], v[22:23] op_sel_hi:[1,0]
    v_pk_fma_f32 v[40:41], v[44:45], v[20:21], v[36:37] op_sel:[1,1,0] op_sel_hi:[0,1,1] neg_lo:[1,0,0]
    v_pk_fma_f32 v[42:43], v[46:47], v[22:23], v[38:39] op_sel:[1,1,0] op_sel_hi:[0,1,1] neg_lo:[1,0,0]
    v_cvt_pk_bf16_f32 v62, v40, v41
    v_cvt_pk_bf16_f32 v63, v42, v43
    ds_write_b64 v8, v[62:63] offset:1584
    v_pk_mul_f32 v[36:37], v[40:41], v[20:21] op_sel_hi:[1,0]
    v_pk_mul_f32 v[38:39], v[42:43], v[22:23] op_sel_hi:[1,0]
    v_pk_fma_f32 v[48:49], v[40:41], v[20:21], v[36:37] op_sel:[1,1,0] op_sel_hi:[0,1,1] neg_lo:[1,0,0]
    v_pk_fma_f32 v[50:51], v[42:43], v[22:23], v[38:39] op_sel:[1,1,0] op_sel_hi:[0,1,1] neg_lo:[1,0,0]
    v_cvt_pk_bf16_f32 v56, v48, v49
    v_cvt_pk_bf16_f32 v57, v50, v51
    ds_write_b64 v8, v[56:57] offset:2112
    v_pk_mul_f32 v[36:37], v[48:49], v[20:21] op_sel_hi:[1,0]
    v_pk_mul_f32 v[38:39], v[50:51], v[22:23] op_sel_hi:[1,0]
    v_pk_fma_f32 v[40:41], v[48:49], v[20:21], v[36:37] op_sel:[1,1,0] op_sel_hi:[0,1,1] neg_lo:[1,0,0]
    v_pk_fma_f32 v[42:43], v[50:51], v[22:23], v[38:39] op_sel:[1,1,0] op_sel_hi:[0,1,1] neg_lo:[1,0,0]
    v_cvt_pk_bf16_f32 v58, v40, v41
    v_cvt_pk_bf16_f32 v59, v42, v43
    ds_write_b64 v8, v[58:59] offset:2640
    v_pk_mul_f32 v[36:37], v[40:41], v[20:21] op_sel_hi:[1,0]
    v_pk_mul_f32 v[38:39], v[42:43], v[22:23] op_sel_hi:[1,0]
    v_pk_fma_f32 v[52:53], v[40:41], v[20:21], v[36:37] op_sel:[1,1,0] op_sel_hi:[0,1,1] neg_lo:[1,0,0]
    v_pk_fma_f32 v[54:55], v[42:43], v[22:23], v[38:39] op_sel:[1,1,0] op_sel_hi:[0,1,1] neg_lo:[1,0,0]
    v_cvt_pk_bf16_f32 v60, v52, v53
    v_cvt_pk_bf16_f32 v61, v54, v55
    ds_write_b64 v8, v[60:61] offset:3168
    v_pk_mul_f32 v[36:37], v[52:53], v[20:21] op_sel_hi:[1,0]
    v_pk_mul_f32 v[38:39], v[54:55], v[22:23] op_sel_hi:[1,0]
    v_pk_fma_f32 v[40:41], v[52:53], v[20:21], v[36:37] op_sel:[1,1,0] op_sel_hi:[0,1,1] neg_lo:[1,0,0]
    v_pk_fma_f32 v[42:43], v[54:55], v[22:23], v[38:39] op_sel:[1,1,0] op_sel_hi:[0,1,1] neg_lo:[1,0,0]
    v_cvt_pk_bf16_f32 v62, v40, v41
    v_cvt_pk_bf16_f32 v63, v42, v43
    ds_write_b64 v8, v[62:63] offset:3696
    v_pk_mul_f32 v[36:37], v[32:33], v[28:29] op_sel_hi:[1,0]
    v_pk_mul_f32 v[38:39], v[34:35], v[30:31] op_sel_hi:[1,0]
    v_pk_fma_f32 v[32:33], v[32:33], v[28:29], v[36:37] op_sel:[1,1,0] op_sel_hi:[0,1,1] neg_lo:[1,0,0]
    v_pk_fma_f32 v[34:35], v[34:35], v[30:31], v[38:39] op_sel:[1,1,0] op_sel_hi:[0,1,1] neg_lo:[1,0,0]
    v_cvt_pk_bf16_f32 v56, v32, v33
    v_cvt_pk_bf16_f32 v57, v34, v35
    ds_write_b64 v8, v[56:57] offset:4224
    v_pk_mul_f32 v[36:37], v[32:33], v[28:29] op_sel_hi:[1,0]
    v_pk_mul_f32 v[38:39], v[34:35], v[30:31] op_sel_hi:[1,0]
    v_pk_fma_f32 v[32:33], v[32:33], v[28:29], v[36:37] op_sel:[1,1,0] op_sel_hi:[0,1,1] neg_lo:[1,0,0]
    v_pk_fma_f32 v[34:35], v[34:35], v[30:31], v[38:39] op_sel:[1,1,0] op_sel_hi:[0,1,1] neg_lo:[1,0,0]
    v_cvt_pk_bf16_f32 v58, v32, v33
    v_cvt_pk_bf16_f32 v59, v34, v35
    ds_write_b64 v8, v[58:59] offset:6336
    v_pk_mul_f32 v[36:37], v[32:33], v[28:29] op_sel_hi:[1,0]
    v_pk_mul_f32 v[38:39], v[34:35], v[30:31] op_sel_hi:[1,0]
    v_pk_fma_f32 v[32:33], v[32:33], v[28:29], v[36:37] op_sel:[1,1,0] op_sel_hi:[0,1,1] neg_lo:[1,0,0]
    v_pk_fma_f32 v[34:35], v[34:35], v[30:31], v[38:39] op_sel:[1,1,0] op_sel_hi:[0,1,1] neg_lo:[1,0,0]
    v_cvt_pk_bf16_f32 v60, v32, v33
    v_cvt_pk_bf16_f32 v61, v34, v35
    ds_write_b64 v8, v[60:61] offset:4752
    v_pk_mul_f32 v[36:37], v[32:33], v[28:29] op_sel_hi:[1,0]
    v_pk_mul_f32 v[38:39], v[34:35], v[30:31] op_sel_hi:[1,0]
    v_pk_fma_f32 v[32:33], v[32:33], v[28:29], v[36:37] op_sel:[1,1,0] op_sel_hi:[0,1,1] neg_lo:[1,0,0]
    v_pk_fma_f32 v[34:35], v[34:35], v[30:31], v[38:39] op_sel:[1,1,0] op_sel_hi:[0,1,1] neg_lo:[1,0,0]
    v_cvt_pk_bf16_f32 v62, v32, v33
    v_cvt_pk_bf16_f32 v63, v34, v35
    ds_write_b64 v8, v[62:63] offset:6864
    v_pk_mul_f32 v[36:37], v[32:33], v[28:29] op_sel_hi:[1,0]
    v_pk_mul_f32 v[38:39], v[34:35], v[30:31] op_sel_hi:[1,0]
    v_pk_fma_f32 v[32:33], v[32:33], v[28:29], v[36:37] op_sel:[1,1,0] op_sel_hi:[0,1,1] neg_lo:[1,0,0]
    v_pk_fma_f32 v[34:35], v[34:35], v[30:31], v[38:39] op_sel:[1,1,0] op_sel_hi:[0,1,1] neg_lo:[1,0,0]
    v_cvt_pk_bf16_f32 v56, v32, v33
    v_cvt_pk_bf16_f32 v57, v34, v35
    ds_write_b64 v8, v[56:57] offset:5280
    v_pk_mul_f32 v[36:37], v[32:33], v[28:29] op_sel_hi:[1,0]
    v_pk_mul_f32 v[38:39], v[34:35], v[30:31] op_sel_hi:[1,0]
    v_pk_fma_f32 v[32:33], v[32:33], v[28:29], v[36:37] op_sel:[1,1,0] op_sel_hi:[0,1,1] neg_lo:[1,0,0]
    v_pk_fma_f32 v[34:35], v[34:35], v[30:31], v[38:39] op_sel:[1,1,0] op_sel_hi:[0,1,1] neg_lo:[1,0,0]
    v_cvt_pk_bf16_f32 v58, v32, v33
    v_cvt_pk_bf16_f32 v59, v34, v35
    ds_write_b64 v8, v[58:59] offset:7392
    v_pk_mul_f32 v[36:37], v[32:33], v[28:29] op_sel_hi:[1,0]
    v_pk_mul_f32 v[38:39], v[34:35], v[30:31] op_sel_hi:[1,0]
    v_pk_fma_f32 v[32:33], v[32:33], v[28:29], v[36:37] op_sel:[1,1,0] op_sel_hi:[0,1,1] neg_lo:[1,0,0]
    v_pk_fma_f32 v[34:35], v[34:35], v[30:31], v[38:39] op_sel:[1,1,0] op_sel_hi:[0,1,1] neg_lo:[1,0,0]
    v_cvt_pk_bf16_f32 v60, v32, v33
    v_cvt_pk_bf16_f32 v61, v34, v35
    ds_write_b64 v8, v[60:61] offset:5808
    v_pk_mul_f32 v[36:37], v[32:33], v[28:29] op_sel_hi:[1,0]
    v_pk_mul_f32 v[38:39], v[34:35], v[30:31] op_sel_hi:[1,0]
    v_pk_fma_f32 v[32:33], v[32:33], v[28:29], v[36:37] op_sel:[1,1,0] op_sel_hi:[0,1,1] neg_lo:[1,0,0]
    v_pk_fma_f32 v[34:35], v[34:35], v[30:31], v[38:39] op_sel:[1,1,0] op_sel_hi:[0,1,1] neg_lo:[1,0,0]
    v_cvt_pk_bf16_f32 v62, v32, v33
    v_cvt_pk_bf16_f32 v63, v34, v35
    ds_write_b64 v8, v[62:63] offset:7920
    v_pk_mul_f32 v[36:37], v[44:45], v[28:29] op_sel_hi:[1,0]
    v_pk_mul_f32 v[38:39], v[46:47], v[30:31] op_sel_hi:[1,0]
    v_pk_fma_f32 v[44:45], v[44:45], v[28:29], v[36:37] op_sel:[1,1,0] op_sel_hi:[0,1,1] neg_lo:[1,0,0]
    v_pk_fma_f32 v[46:47], v[46:47], v[30:31], v[38:39] op_sel:[1,1,0] op_sel_hi:[0,1,1] neg_lo:[1,0,0]
    v_cvt_pk_bf16_f32 v56, v44, v45
    v_cvt_pk_bf16_f32 v57, v46, v47
    ds_write_b64 v8, v[56:57] offset:8448
    v_pk_mul_f32 v[36:37], v[48:49], v[28:29] op_sel_hi:[1,0]
    v_pk_mul_f32 v[38:39], v[50:51], v[30:31] op_sel_hi:[1,0]
    v_pk_fma_f32 v[48:49], v[48:49], v[28:29], v[36:37] op_sel:[1,1,0] op_sel_hi:[0,1,1] neg_lo:[1,0,0]
    v_pk_fma_f32 v[50:51], v[50:51], v[30:31], v[38:39] op_sel:[1,1,0] op_sel_hi:[0,1,1] neg_lo:[1,0,0]
    v_cvt_pk_bf16_f32 v58, v48, v49
    v_cvt_pk_bf16_f32 v59, v50, v51
    ds_write_b64 v8, v[58:59] offset:8976
    v_pk_mul_f32 v[36:37], v[52:53], v[28:29] op_sel_hi:[1,0]
    v_pk_mul_f32 v[38:39], v[54:55], v[30:31] op_sel_hi:[1,0]
    v_pk_fma_f32 v[52:53], v[52:53], v[28:29], v[36:37] op_sel:[1,1,0] op_sel_hi:[0,1,1] neg_lo:[1,0,0]
    v_pk_fma_f32 v[54:55], v[54:55], v[30:31], v[38:39] op_sel:[1,1,0] op_sel_hi:[0,1,1] neg_lo:[1,0,0]
    v_cvt_pk_bf16_f32 v60, v52, v53
    v_cvt_pk_bf16_f32 v61, v54, v55
    ds_write_b64 v8, v[60:61] offset:9504
    v_pk_mul_f32 v[36:37], v[48:49], v[28:29] op_sel_hi:[1,0]
    v_pk_mul_f32 v[38:39], v[50:51], v[30:31] op_sel_hi:[1,0]
    v_pk_fma_f32 v[48:49], v[48:49], v[28:29], v[36:37] op_sel:[1,1,0] op_sel_hi:[0,1,1] neg_lo:[1,0,0]
    v_pk_fma_f32 v[50:51], v[50:51], v[30:31], v[38:39] op_sel:[1,1,0] op_sel_hi:[0,1,1] neg_lo:[1,0,0]
    v_cvt_pk_bf16_f32 v62, v48, v49
    v_cvt_pk_bf16_f32 v63, v50, v51
    ds_write_b64 v8, v[62:63] offset:10560
    v_pk_mul_f32 v[36:37], v[48:49], v[28:29] op_sel_hi:[1,0]
    v_pk_mul_f32 v[38:39], v[50:51], v[30:31] op_sel_hi:[1,0]
    v_pk_fma_f32 v[48:49], v[48:49], v[28:29], v[36:37] op_sel:[1,1,0] op_sel_hi:[0,1,1] neg_lo:[1,0,0]
    v_pk_fma_f32 v[50:51], v[50:51], v[30:31], v[38:39] op_sel:[1,1,0] op_sel_hi:[0,1,1] neg_lo:[1,0,0]
    v_cvt_pk_bf16_f32 v56, v48, v49
    v_cvt_pk_bf16_f32 v57, v50, v51
    ds_write_b64 v8, v[56:57] offset:10032
    ds_read_b128 v[128:131], v11 offset:0
    ds_read_b128 v[132:135], v11 offset:32
    ds_read_b128 v[136:139], v11 offset:64
    ds_read_b128 v[140:143], v11 offset:96
    ds_read_b128 v[144:147], v11 offset:128
    ds_read_b128 v[148:151], v11 offset:160
    ds_read_b128 v[152:155], v11 offset:192
    ds_read_b128 v[156:159], v11 offset:224
    ds_read_b128 v[160:163], v11 offset:256
    ds_read_b128 v[164:167], v11 offset:288
    ds_read_b128 v[168:171], v11 offset:320
    ds_read_b128 v[172:175], v11 offset:352
    ds_read_b128 v[176:179], v11 offset:384
    ds_read_b128 v[180:183], v11 offset:416
    ds_read_b128 v[184:187], v11 offset:448
    ds_read_b128 v[188:191], v11 offset:480
    s_mul_i32 s5, s3, 3072
    s_add_u32 s5, s5, 67584
    v_add_u32 v12, s5, v5
    s_xor_b32 s6, s3, 1
    s_mul_i32 s6, s6, 3072
    s_add_u32 s6, s6, 67584
    v_add_u32 v13, s6, v5
    s_waitcnt lgkmcnt(15)
    v_mfma_f32_32x32x16_bf16 v[192:207], v[128:131], v[64:67], 0
    s_waitcnt lgkmcnt(14)
    v_mfma_f32_32x32x16_bf16 v[192:207], v[132:135], v[68:71], v[192:207]
    s_waitcnt lgkmcnt(13)
    v_mfma_f32_32x32x16_bf16 v[192:207], v[136:139], v[72:75], v[192:207]
    s_waitcnt lgkmcnt(12)
    v_mfma_f32_32x32x16_bf16 v[192:207], v[140:143], v[76:79], v[192:207]
    s_waitcnt lgkmcnt(11)
    v_mfma_f32_32x32x16_bf16 v[192:207], v[144:147], v[80:83], v[192:207]
    s_waitcnt lgkmcnt(10)
    v_mfma_f32_32x32x16_bf16 v[192:207], v[148:151], v[84:87], v[192:207]
    s_waitcnt lgkmcnt(9)
    v_mfma_f32_32x32x16_bf16 v[192:207], v[152:155], v[88:91], v[192:207]
    s_waitcnt lgkmcnt(8)
    v_mfma_f32_32x32x16_bf16 v[192:207], v[156:159], v[92:95], v[192:207]
    s_waitcnt lgkmcnt(7)
    v_mfma_f32_32x32x16_bf16 v[192:207], v[160:163], v[96:99], v[192:207]
    s_waitcnt lgkmcnt(6)
    v_mfma_f32_32x32x16_bf16 v[192:207], v[164:167], v[100:103], v[192:207]
    s_waitcnt lgkmcnt(5)
    v_mfma_f32_32x32x16_bf16 v[192:207], v[168:171], v[104:107], v[192:207]
    s_waitcnt lgkmcnt(4)
    v_mfma_f32_32x32x16_bf16 v[192:207], v[172:175], v[108:111], v[192:207]
    s_waitcnt lgkmcnt(3)
    v_mfma_f32_32x32x16_bf16 v[192:207], v[176:179], v[112:115], v[192:207]
    s_waitcnt lgkmcnt(2)
    v_mfma_f32_32x32x16_bf16 v[192:207], v[180:183], v[116:119], v[192:207]
    s_waitcnt lgkmcnt(1)
    v_mfma_f32_32x32x16_bf16 v[192:207], v[184:187], v[120:123], v[192:207]
    s_waitcnt lgkmcnt(0)
    v_mfma_f32_32x32x16_bf16 v[192:207], v[188:191], v[124:127], v[192:207]
    s_lshr_b32 s5, s3, 1
    s_mul_i32 s14, s5, 7680
    v_sub_u32 v14, 223, v1
    v_lshrrev_b32 v15, 1, v14
    v_mul_u32_u24 v15, 48, v15
    v_and_b32 v14, 1, v14
    v_lshl_add_u32 v14, v14, 4, v15
    v_add_u32 v14, s14, v14
    v_mov_b32 v16, 0
    v_mov_b32 v17, 0
    v_mov_b32 v18, 0
    v_mov_b32 v19, 0
    v_add_u32 v15, s14, v5
    s_mov_b32 s74, 0
    s_mov_b32 s75, -1
    s_mov_b32 s76, 0xaaaaaaaa
    s_mov_b32 s77, 0xaaaaaaaa
    ds_write_b128 v12, v[192:195] offset:0
    ds_write_b128 v12, v[196:199] offset:1024
    ds_write_b128 v12, v[200:203] offset:2048
    s_waitcnt lgkmcnt(0)
    s_barrier
    s_setprio 2
    ds_read_b128 v[64:67], v13 offset:0
    ds_read_b128 v[68:71], v13 offset:1024
    ds_read_b128 v[72:75], v13 offset:2048
    s_waitcnt lgkmcnt(0)
    v_pk_add_f32 v[192:193], v[192:193], v[64:65]
    v_pk_add_f32 v[194:195], v[194:195], v[66:67]
    v_pk_add_f32 v[196:197], v[196:197], v[68:69]
    v_pk_add_f32 v[198:199], v[198:199], v[70:71]
    v_pk_add_f32 v[200:201], v[200:201], v[72:73]
    v_pk_add_f32 v[202:203], v[202:203], v[74:75]
    s_bitcmp1_b32 s3, 0
    s_cbranch_scc1 L_s_expB
    ds_write_b128 v15, v[16:19] offset:6144
    v_mov_b32 v32, s73
    v_cmp_eq_u32 vcc, 0, v1
    s_nop 1
    v_cndmask_b32 v32, 0, v32, vcc
    v_add_f32 v192, v192, v32
    v_and_b32 v33, 31, v1
    v_sub_u32 v33, 255, v33
    v_lshrrev_b32 v34, 1, v33
    v_mul_u32_u24 v34, 48, v34
    v_and_b32 v33, 1, v33
    v_lshl_add_u32 v33, v33, 4, v34
    v_add_u32 v33, s14, v33
    v_add_u32 v34, 8, v33
    v_cndmask_b32 v33, v34, v33, s[74:75]
    v_cvt_pk_bf16_f32 v36, v195, v194
    v_cvt_pk_bf16_f32 v37, v193, v192
    ds_write_b64 v33, v[36:37]
    v_mov_b32_dpp v40, v197 wave_rol:1 row_mask:0xf bank_mask:0xf
    s_nop 1
    v_mov_b32_dpp v40, v196 wave_shl:1 row_mask:0xf bank_mask:0xf
    v_cndmask_b32 v41, v202, v40, s[74:75]
    v_cndmask_b32 v42, v201, v200, s[74:75]
    v_cndmask_b32 v43, v200, v196, s[74:75]
    v_cvt_pk_bf16_f32 v44, v40, v41
    v_cvt_pk_bf16_f32 v45, v42, v42
    v_cvt_pk_bf16_f32 v46, v42, v43
    v_cvt_pk_bf16_f32 v47, v196, v196
    ds_write_b128 v14, v[44:47]
    s_branch L_s_expJ
L_s_expB:
    v_subrev_u32 v14, 3072, v14
    v_mov_b32_dpp v40, v198 wave_rol:1 row_mask:0xf bank_mask:0xf
    s_nop 1
    v_mov_b32_dpp v40, v197 wave_shl:1 row_mask:0xf bank_mask:0xf
    v_cndmask_b32 v41, v197, v40, s[76:77]
    v_cndmask_b32 v42, v203, v40, s[74:75]
    v_cndmask_b32 v41, v203, v41, s[74:75]
    v_cndmask_b32 v43, v203, v197, s[74:75]
    v_cvt_pk_bf16_f32 v44, v40, v40
    v_cvt_pk_bf16_f32 v45, v42, v41
    v_cvt_pk_bf16_f32 v46, v43, v197
    v_cvt_pk_bf16_f32 v47, v197, v197
    ds_write_b128 v14, v[44:47] offset:1536
    v_mov_b32_dpp v48, v199 wave_rol:1 row_mask:0xf bank_mask:0xf
    s_nop 1
    v_mov_b32_dpp v48, v198 wave_shl:1 row_mask:0xf bank_mask:0xf
    v_cndmask_b32 v49, v198, v48, s[76:77]
    v_cvt_pk_bf16_f32 v52, v48, v48
    v_cvt_pk_bf16_f32 v53, v48, v49
    v_cvt_pk_bf16_f32 v54, v198, v198
    v_cvt_pk_bf16_f32 v55, v198, v198
    ds_write_b128 v14, v[52:55]
    v_mov_b32_dpp v56, v199 wave_shl:1 row_mask:0xf bank_mask:0xf
    v_cndmask_b32 v57, v199, v56, s[76:77]
    v_cvt_pk_bf16_f32 v60, v56, v56
    v_cvt_pk_bf16_f32 v61, v56, v57
    v_cvt_pk_bf16_f32 v62, v199, v199
    v_cvt_pk_bf16_f32 v63, v199, v199
    v_subrev_u32 v14, 1536, v14
    s_mov_b32 exec_hi, 0
    ds_write_b128 v14, v[60:63]
    s_mov_b32 exec_hi, -1
L_s_expJ:
    s_lshr_b32 s5, s15, 5
    s_lshl_b32 s5, s5, 13
    s_add_u32 s5, s5, 0x7000c
    v_lshlrev_b32 v13, 7, v1
    v_add_u32 v13, s5, v13
    v_lshrrev_b32 v10, 1, v1
    v_and_b32 v11, 1, v1
    v_mul_u32_u24 v12, 7168, v10
    v_lshl_add_u32 v12, v11, 4, v12
    s_mul_i32 s74, s3, 458752
    s_lshl_b32 s5, s15, 5
    s_add_u32 s74, s74, s5
    s_add_u32 s74, s74, 0x600000
    s_add_u32 s75, s74, 229376
    v_mul_u32_u24 v15, 16640, v11
    v_lshl_add_u32 v15, v10, 4, v15
    s_lshl_b32 s5, s3, 10
    s_add_u32 s5, s5, 15360
    v_add_u32 v15, s5, v15
    s_cmp_lg_u32 s3, 0
    s_cbranch_scc1 L_s_nohead
    v_mov_b32 v16, 0
    v_mov_b32 v17, 0
    v_mov_b32 v18, 0
    v_mov_b32 v19, 0
    v_bfe_u32 v22, v1, 2, 3
    v_mul_u32_u24 v22, 4160, v22
    v_and_b32 v23, 3, v1
    v_lshl_add_u32 v22, v23, 4, v22
    ds_write_b128 v22, v[16:19] offset:15360
L_s_nohead:
    s_mov_b32 s5, 0
L_poll_xt:
    buffer_load_dword v14, v13, s[56:59], 0 offen sc1
    s_waitcnt vmcnt(0)
    v_cmp_ne_u32 vcc, s4, v14
    s_nop 1
    s_cmp_eq_u64 vcc, 0
    s_cbranch_scc1 L_pollok_xt
    s_mov_b64 exec, vcc
    s_sleep 2
    s_add_u32 s5, s5, 1
    s_cmp_lt_u32 s5, 400000
    s_cbranch_scc1 L_poll_xt
L_pollok_xt:
    s_mov_b64 exec, -1
    s_setprio 2
    buffer_load_dwordx4 v[16:19], v12, s[56:59], s74 offen sc1
    buffer_load_dwordx4 v[20:23], v12, s[56:59], s75 offen sc1
    v_and_b32 v13, 7, v1
    v_lshlrev_b32 v13, 7, v13
    buffer_load_dword v14, v13, s[56:59], s86 offen sc1
    v_add_u32 v24, 4220, v15
    v_add_u32 v25, 12536, v15
    v_add_u32 v26, 8376, v15
    s_waitcnt vmcnt(2)
    v_alignbit_b32 v28, v17, v16, 16
    v_alignbit_b32 v29, v18, v17, 16
    v_alignbit_b32 v30, v19, v18, 16
    ds_write2_b32 v24, v16, v17 offset0:0 offset1:1
    ds_write2_b32 v24, v18, v19 offset0:2 offset1:3
    ds_write2_b32 v25, v16, v17 offset0:0 offset1:1
    ds_write2_b32 v25, v18, v19 offset0:2 offset1:3
    ds_write_b16 v15, v16 offset:62
    ds_write2_b32 v15, v28, v29 offset0:16 offset1:17
    ds_write_b32 v15, v30 offset:72
    ds_write_b16_d16_hi v15, v19 offset:76
    ds_write_b16 v26, v16 offset:2
    ds_write2_b32 v26, v28, v29 offset0:1 offset1:2
    ds_write_b32 v26, v30 offset:12
    ds_write_b16_d16_hi v26, v19 offset:16
    s_waitcnt vmcnt(1)
    v_alignbit_b32 v28, v21, v20, 16
    v_alignbit_b32 v29, v22, v21, 16
    v_alignbit_b32 v30, v23, v22, 16
    ds_write2_b32 v24, v20, v21 offset0:128 offset1:129
    ds_write2_b32 v24, v22, v23 offset0:130 offset1:131
    ds_write2_b32 v25, v20, v21 offset0:128 offset1:129
    ds_write2_b32 v25, v22, v23 offset0:130 offset1:131
    ds_write_b16 v15, v20 offset:574
    ds_write2_b32 v15, v28, v29 offset0:144 offset1:145
    ds_write_b32 v15, v30 offset:584
    ds_write_b16_d16_hi v15, v23 offset:588
    ds_write_b16 v26, v20 offset:514
    ds_write2_b32 v26, v28, v29 offset0:129 offset1:130
    ds_write_b32 v26, v30 offset:524
    ds_write_b16_d16_hi v26, v23 offset:528
    v_and_b32 v10, 3, v1
    v_mul_u32_u24 v8, 4160, v10
    v_bfe_u32 v10, v1, 2, 2
    v_lshl_add_u32 v8, v10, 3, v8
    v_lshrrev_b32 v10, 4, v1
    v_lshl_add_u32 v8, v10, 4, v8
    v_and_b32 v11, 15, v1
    v_sub_u32 v11, 15, v11
    v_lshrrev_b32 v12, 5, v1
    v_add_u32 v11, v11, v12
    v_mul_u32_u24 v9, 48, v11
    v_and_b32 v10, 1, v10
    v_lshl_add_u32 v9, v10, 4, v9
    s_lshr_b32 s5, s3, 1
    s_mul_i32 s5, s5, 16640
    s_add_u32 s5, s5, 15392
    s_and_b32 s6, s3, 1
    s_lshl_b32 s7, s6, 8
    s_add_u32 s5, s5, s7
    v_add_u32 v8, s5, v8
    s_mul_i32 s7, s6, 384
    s_add_u32 s7, s7, s14
    v_add_u32 v9, s7, v9
    s_waitcnt vmcnt(0)
    v_cmp_ne_u32 vcc, s4, v14
    s_nop 1
    s_cmp_eq_u64 vcc, 0
    s_cselect_b32 s87, 1, 0
    s_cselect_b32 s90, 32768, 0
    s_cmp_lg_u32 s3, s85
    s_cselect_b32 s87, 1, s87
    s_cselect_b32 s90, 0, s90
    s_waitcnt lgkmcnt(0)
    s_barrier
    ds_read_b128 v[48:51], v9 offset:5376
    ds_read_b64 v[80:81], v8 offset:0
    ds_read_b64 v[82:83], v8 offset:8
    ds_read_b128 v[52:55], v9 offset:4608
    ds_read_b64 v[84:85], v8 offset:512
    ds_read_b64 v[86:87], v8 offset:520
    ds_read_b128 v[56:59], v9 offset:3840
    ds_read_b64 v[88:89], v8 offset:1024
    ds_read_b64 v[90:91], v8 offset:1032
    ds_read_b128 v[60:63], v9 offset:3072
    ds_read_b64 v[92:93], v8 offset:1536
    ds_read_b64 v[94:95], v8 offset:1544
    ds_read_b128 v[64:67], v9 offset:2304
    ds_read_b64 v[96:97], v8 offset:2048
    ds_read_b64 v[98:99], v8 offset:2056
    ds_read_b128 v[68:71], v9 offset:1536
    ds_read_b64 v[100:101], v8 offset:2560
    ds_read_b64 v[102:103], v8 offset:2568
    ds_read_b128 v[72:75], v9 offset:768
    ds_read_b64 v[104:105], v8 offset:3072
    ds_read_b64 v[106:107], v8 offset:3080
    ds_read_b128 v[76:79], v9 offset:0
    ds_read_b64 v[108:109], v8 offset:3584
    ds_read_b64 v[110:111], v8 offset:3592
    s_setprio 0
    s_waitcnt lgkmcnt(0)
    v_mfma_f32_16x16x32_bf16 v[16:19], v[48:51], v[80:83], 0
    ds_read_b128 v[112:115], v9 offset:5472
    v_mfma_f32_16x16x32_bf16 v[20:23], v[52:55], v[80:83], 0
    ds_read_b64 v[144:145], v8 offset:64
    v_mfma_f32_16x16x32_bf16 v[24:27], v[56:59], v[80:83], 0
    ds_read_b64 v[146:147], v8 offset:72
    v_mfma_f32_16x16x32_bf16 v[28:31], v[60:63], v[80:83], 0
    ds_read_b128 v[116:119], v9 offset:4704
    s_movk_i32 s6, 0x3000
    buffer_load_dwordx4 v[176:179], v5, s[88:91], s6 offen offset:0 sc1
    v_mfma_f32_16x16x32_bf16 v[32:35], v[64:67], v[80:83], 0
    ds_read_b64 v[148:149], v8 offset:576
    v_mfma_f32_16x16x32_bf16 v[36:39], v[68:71], v[80:83], 0
    ds_read_b64 v[150:151], v8 offset:584
    v_mfma_f32_16x16x32_bf16 v[40:43], v[72:75], v[80:83], 0
    ds_read_b128 v[120:123], v9 offset:3936
    v_mfma_f32_16x16x32_bf16 v[44:47], v[76:79], v[80:83], 0
    ds_read_b64 v[152:153], v8 offset:1088
    v_mfma_f32_16x16x32_bf16 v[20:23], v[48:51], v[84:87], v[20:23]
    ds_read_b64 v[154:155], v8 offset:1096
    v_mfma_f32_16x16x32_bf16 v[24:27], v[52:55], v[84:87], v[24:27]
    ds_read_b128 v[124:127], v9 offset:3168
    v_mfma_f32_16x16x32_bf16 v[28:31], v[56:59], v[84:87], v[28:31]
    ds_read_b64 v[156:157], v8 offset:1600
    s_movk_i32 s6, 0x3000
    buffer_load_dwordx4 v[180:183], v5, s[88:91], s6 offen offset:1024 sc1
    v_mfma_f32_16x16x32_bf16 v[32:35], v[60:63], v[84:87], v[32:35]
    ds_read_b64 v[158:159], v8 offset:1608
    v_mfma_f32_16x16x32_bf16 v[36:39], v[64:67], v[84:87], v[36:39]
    ds_read_b128 v[128:131], v9 offset:2400
    v_mfma_f32_16x16x32_bf16 v[40:43], v[68:71], v[84:87], v[40:43]
    ds_read_b64 v[160:161], v8 offset:2112
    v_mfma_f32_16x16x32_bf16 v[44:47], v[72:75], v[84:87], v[44:47]
    ds_read_b64 v[162:163], v8 offset:2120
    v_mfma_f32_16x16x32_bf16 v[24:27], v[48:51], v[88:91], v[24:27]
    ds_read_b128 v[132:135], v9 offset:1632
    v_mfma_f32_16x16x32_bf16 v[28:31], v[52:55], v[88:91], v[28:31]
    ds_read_b64 v[164:165], v8 offset:2624
    v_mfma_f32_16x16x32_bf16 v[32:35], v[56:59], v[88:91], v[32:35]
    ds_read_b64 v[166:167], v8 offset:2632
    s_movk_i32 s6, 0x3000
    buffer_load_dwordx4 v[184:187], v5, s[88:91], s6 offen offset:2048 sc1
    v_mfma_f32_16x16x32_bf16 v[36:39], v[60:63], v[88:91], v[36:39]
    ds_read_b128 v[136:139], v9 offset:864
    v_mfma_f32_16x16x32_bf16 v[40:43], v[64:67], v[88:91], v[40:43]
    ds_read_b64 v[168:169], v8 offset:3136
    v_mfma_f32_16x16x32_bf16 v[44:47], v[68:71], v[88:91], v[44:47]
    ds_read_b64 v[170:171], v8 offset:3144
    v_mfma_f32_16x16x32_bf16 v[28:31], v[48:51], v[92:95], v[28:31]
    ds_read_b128 v[140:143], v9 offset:96
    v_mfma_f32_16x16x32_bf16 v[32:35], v[52:55], v[92:95], v[32:35]
    ds_read_b64 v[172:173], v8 offset:3648
    v_mfma_f32_16x16x32_bf16 v[36:39], v[56:59], v[92:95], v[36:39]
    ds_read_b64 v[174:175], v8 offset:3656
    v_mfma_f32_16x16x32_bf16 v[40:43], v[60:63], v[92:95], v[40:43]
    s_movk_i32 s6, 0x3000
    buffer_load_dwordx4 v[188:191], v5, s[88:91], s6 offen offset:3072 sc1
    v_mfma_f32_16x16x32_bf16 v[44:47], v[64:67], v[92:95], v[44:47]
    v_mfma_f32_16x16x32_bf16 v[32:35], v[48:51], v[96:99], v[32:35]
    v_mfma_f32_16x16x32_bf16 v[36:39], v[52:55], v[96:99], v[36:39]
    v_mfma_f32_16x16x32_bf16 v[40:43], v[56:59], v[96:99], v[40:43]
    v_mfma_f32_16x16x32_bf16 v[44:47], v[60:63], v[96:99], v[44:47]
    v_mfma_f32_16x16x32_bf16 v[36:39], v[48:51], v[100:103], v[36:39]
    v_mfma_f32_16x16x32_bf16 v[40:43], v[52:55], v[100:103], v[40:43]
    s_movk_i32 s6, 0x4000
    buffer_load_dwordx4 v[192:195], v5, s[88:91], s6 offen offset:0 sc1
    v_mfma_f32_16x16x32_bf16 v[44:47], v[56:59], v[100:103], v[44:47]
    v_mfma_f32_16x16x32_bf16 v[40:43], v[48:51], v[104:107], v[40:43]
    v_mfma_f32_16x16x32_bf16 v[44:47], v[52:55], v[104:107], v[44:47]
    v_mfma_f32_16x16x32_bf16 v[44:47], v[48:51], v[108:111], v[44:47]
    s_waitcnt lgkmcnt(0)
    v_mfma_f32_16x16x32_bf16 v[16:19], v[112:115], v[144:147], v[16:19]
    ds_read_b128 v[48:51], v9 offset:5568
    v_mfma_f32_16x16x32_bf16 v[20:23], v[116:119], v[144:147], v[20:23]
    ds_read_b64 v[80:81], v8 offset:128
    v_mfma_f32_16x16x32_bf16 v[24:27], v[120:123], v[144:147], v[24:27]
    ds_read_b64 v[82:83], v8 offset:136
    v_mfma_f32_16x16x32_bf16 v[28:31], v[124:127], v[144:147], v[28:31]
    ds_read_b128 v[52:55], v9 offset:4800
    s_movk_i32 s6, 0x4000
    buffer_load_dwordx4 v[196:199], v5, s[88:91], s6 offen offset:1024 sc1
    v_mfma_f32_16x16x32_bf16 v[32:35], v[128:131], v[144:147], v[32:35]
    ds_read_b64 v[84:85], v8 offset:640
    v_mfma_f32_16x16x32_bf16 v[36:39], v[132:135], v[144:147], v[36:39]
    ds_read_b64 v[86:87], v8 offset:648
    v_mfma_f32_16x16x32_bf16 v[40:43], v[136:139], v[144:147], v[40:43]
    ds_read_b128 v[56:59], v9 offset:4032
    v_mfma_f32_16x16x32_bf16 v[44:47], v[140:143], v[144:147], v[44:47]
    ds_read_b64 v[88:89], v8 offset:1152
    v_mfma_f32_16x16x32_bf16 v[20:23], v[112:115], v[148:151], v[20:23]
    ds_read_b64 v[90:91], v8 offset:1160
    v_mfma_f32_16x16x32_bf16 v[24:27], v[116:119], v[148:151], v[24:27]
    ds_read_b128 v[60:63], v9 offset:3264
    v_mfma_f32_16x16x32_bf16 v[28:31], v[120:123], v[148:151], v[28:31]
    ds_read_b64 v[92:93], v8 offset:1664
    s_movk_i32 s6, 0x4000
    buffer_load_dwordx4 v[200:203], v5, s[88:91], s6 offen offset:2048 sc1
    v_mfma_f32_16x16x32_bf16 v[32:35], v[124:127], v[148:151], v[32:35]
    ds_read_b64 v[94:95], v8 offset:1672
    v_mfma_f32_16x16x32_bf16 v[36:39], v[128:131], v[148:151], v[36:39]
    ds_read_b128 v[64:67], v9 offset:2496
    v_mfma_f32_16x16x32_bf16 v[40:43], v[132:135], v[148:151], v[40:43]
    ds_read_b64 v[96:97], v8 offset:2176
    v_mfma_f32_16x16x32_bf16 v[44:47], v[136:139], v[148:151], v[44:47]
    ds_read_b64 v[98:99], v8 offset:2184
    v_mfma_f32_16x16x32_bf16 v[24:27], v[112:115], v[152:155], v[24:27]
    ds_read_b128 v[68:71], v9 offset:1728
    v_mfma_f32_16x16x32_bf16 v[28:31], v[116:119], v[152:155], v[28:31]
    ds_read_b64 v[100:101], v8 offset:2688
    v_mfma_f32_16x16x32_bf16 v[32:35], v[120:123], v[152:155], v[32:35]
    ds_read_b64 v[102:103], v8 offset:2696
    s_movk_i32 s6, 0x4000
    buffer_load_dwordx4 v[204:207], v5, s[88:91], s6 offen offset:3072 sc1
    v_mfma_f32_16x16x32_bf16 v[36:39], v[124:127], v[152:155], v[36:39]
    ds_read_b128 v[72:75], v9 offset:960
    v_mfma_f32_16x16x32_bf16 v[40:43], v[128:131], v[152:155], v[40:43]
    ds_read_b64 v[104:105], v8 offset:3200
    v_mfma_f32_16x16x32_bf16 v[44:47], v[132:135], v[152:155], v[44:47]
    ds_read_b64 v[106:107], v8 offset:3208
    v_mfma_f32_16x16x32_bf16 v[28:31], v[112:115], v[156:159], v[28:31]
    ds_read_b128 v[76:79], v9 offset:192
    v_mfma_f32_16x16x32_bf16 v[32:35], v[116:119], v[156:159], v[32:35]
    ds_read_b64 v[108:109], v8 offset:3712
    v_mfma_f32_16x16x32_bf16 v[36:39], v[120:123], v[156:159], v[36:39]
    ds_read_b64 v[110:111], v8 offset:3720
    v_mfma_f32_16x16x32_bf16 v[40:43], v[124:127], v[156:159], v[40:43]
    s_movk_i32 s6, 0x5000
    buffer_load_dwordx4 v[208:211], v5, s[88:91], s6 offen offset:0 sc1
    v_mfma_f32_16x16x32_bf16 v[44:47], v[128:131], v[156:159], v[44:47]
    v_mfma_f32_16x16x32_bf16 v[32:35], v[112:115], v[160:163], v[32:35]
    v_mfma_f32_16x16x32_bf16 v[36:39], v[116:119], v[160:163], v[36:39]
    v_mfma_f32_16x16x32_bf16 v[40:43], v[120:123], v[160:163], v[40:43]
    v_mfma_f32_16x16x32_bf16 v[44:47], v[124:127], v[160:163], v[44:47]
    v_mfma_f32_16x16x32_bf16 v[36:39], v[112:115], v[164:167], v[36:39]
    v_mfma_f32_16x16x32_bf16 v[40:43], v[116:119], v[164:167], v[40:43]
    s_movk_i32 s6, 0x5000
    buffer_load_dwordx4 v[212:215], v5, s[88:91], s6 offen offset:1024 sc1
    v_mfma_f32_16x16x32_bf16 v[44:47], v[120:123], v[164:167], v[44:47]
    v_mfma_f32_16x16x32_bf16 v[40:43], v[112:115], v[168:171], v[40:43]
    v_mfma_f32_16x16x32_bf16 v[44:47], v[116:119], v[168:171], v[44:47]
    v_mfma_f32_16x16x32_bf16 v[44:47], v[112:115], v[172:175], v[44:47]
    s_waitcnt lgkmcnt(0)
    v_mfma_f32_16x16x32_bf16 v[16:19], v[48:51], v[80:83], v[16:19]
    ds_read_b128 v[112:115], v9 offset:5664
    v_mfma_f32_16x16x32_bf16 v[20:23], v[52:55], v[80:83], v[20:23]
    ds_read_b64 v[144:145], v8 offset:192
    v_mfma_f32_16x16x32_bf16 v[24:27], v[56:59], v[80:83], v[24:27]
    ds_read_b64 v[146:147], v8 offset:200
    v_mfma_f32_16x16x32_bf16 v[28:31], v[60:63], v[80:83], v[28:31]
    ds_read_b128 v[116:119], v9 offset:4896
    s_movk_i32 s6, 0x5000
    buffer_load_dwordx4 v[216:219], v5, s[88:91], s6 offen offset:2048 sc1
    v_mfma_f32_16x16x32_bf16 v[32:35], v[64:67], v[80:83], v[32:35]
    ds_read_b64 v[148:149], v8 offset:704
    v_mfma_f32_16x16x32_bf16 v[36:39], v[68:71], v[80:83], v[36:39]
    ds_read_b64 v[150:151], v8 offset:712
    v_mfma_f32_16x16x32_bf16 v[40:43], v[72:75], v[80:83], v[40:43]
    ds_read_b128 v[120:123], v9 offset:4128
    v_mfma_f32_16x16x32_bf16 v[44:47], v[76:79], v[80:83], v[44:47]
    ds_read_b64 v[152:153], v8 offset:1216
    v_mfma_f32_16x16x32_bf16 v[20:23], v[48:51], v[84:87], v[20:23]
    ds_read_b64 v[154:155], v8 offset:1224
    v_mfma_f32_16x16x32_bf16 v[24:27], v[52:55], v[84:87], v[24:27]
    ds_read_b128 v[124:127], v9 offset:3360
    v_mfma_f32_16x16x32_bf16 v[28:31], v[56:59], v[84:87], v[28:31]
    ds_read_b64 v[156:157], v8 offset:1728
    s_movk_i32 s6, 0x5000
    buffer_load_dwordx4 v[220:223], v5, s[88:91], s6 offen offset:3072 sc1
    v_mfma_f32_16x16x32_bf16 v[32:35], v[60:63], v[84:87], v[32:35]
    ds_read_b64 v[158:159], v8 offset:1736
    v_mfma_f32_16x16x32_bf16 v[36:39], v[64:67], v[84:87], v[36:39]
    ds_read_b128 v[128:131], v9 offset:2592
    v_mfma_f32_16x16x32_bf16 v[40:43], v[68:71], v[84:87], v[40:43]
    ds_read_b64 v[160:161], v8 offset:2240
    v_mfma_f32_16x16x32_bf16 v[44:47], v[72:75], v[84:87], v[44:47]
    ds_read_b64 v[162:163], v8 offset:2248
    v_mfma_f32_16x16x32_bf16 v[24:27], v[48:51], v[88:91], v[24:27]
    ds_read_b128 v[132:135], v9 offset:1824
    v_mfma_f32_16x16x32_bf16 v[28:31], v[52:55], v[88:91], v[28:31]
    ds_read_b64 v[164:165], v8 offset:2752
    v_mfma_f32_16x16x32_bf16 v[32:35], v[56:59], v[88:91], v[32:35]
    ds_read_b64 v[166:167], v8 offset:2760
    s_movk_i32 s6, 0x6000
    buffer_load_dwordx4 v[224:227], v5, s[88:91], s6 offen offset:0 sc1
    v_mfma_f32_16x16x32_bf16 v[36:39], v[60:63], v[88:91], v[36:39]
    ds_read_b128 v[136:139], v9 offset:1056
    v_mfma_f32_16x16x32_bf16 v[40:43], v[64:67], v[88:91], v[40:43]
    ds_read_b64 v[168:169], v8 offset:3264
    v_mfma_f32_16x16x32_bf16 v[44:47], v[68:71], v[88:91], v[44:47]
    ds_read_b64 v[170:171], v8 offset:3272
    v_mfma_f32_16x16x32_bf16 v[28:31], v[48:51], v[92:95], v[28:31]
    ds_read_b128 v[140:143], v9 offset:288
    v_mfma_f32_16x16x32_bf16 v[32:35], v[52:55], v[92:95], v[32:35]
    ds_read_b64 v[172:173], v8 offset:3776
    v_mfma_f32_16x16x32_bf16 v[36:39], v[56:59], v[92:95], v[36:39]
    ds_read_b64 v[174:175], v8 offset:3784
    v_mfma_f32_16x16x32_bf16 v[40:43], v[60:63], v[92:95], v[40:43]
    s_movk_i32 s6, 0x6000
    buffer_load_dwordx4 v[228:231], v5, s[88:91], s6 offen offset:1024 sc1
    v_mfma_f32_16x16x32_bf16 v[44:47], v[64:67], v[92:95], v[44:47]
    v_mfma_f32_16x16x32_bf16 v[32:35], v[48:51], v[96:99], v[32:35]
    v_mfma_f32_16x16x32_bf16 v[36:39], v[52:55], v[96:99], v[36:39]
    v_mfma_f32_16x16x32_bf16 v[40:43], v[56:59], v[96:99], v[40:43]
    v_mfma_f32_16x16x32_bf16 v[44:47], v[60:63], v[96:99], v[44:47]
    v_mfma_f32_16x16x32_bf16 v[36:39], v[48:51], v[100:103], v[36:39]
    v_mfma_f32_16x16x32_bf16 v[40:43], v[52:55], v[100:103], v[40:43]
    s_movk_i32 s6, 0x6000
    buffer_load_dwordx4 v[232:235], v5, s[88:91], s6 offen offset:2048 sc1
    v_mfma_f32_16x16x32_bf16 v[44:47], v[56:59], v[100:103], v[44:47]
    v_mfma_f32_16x16x32_bf16 v[40:43], v[48:51], v[104:107], v[40:43]
    v_mfma_f32_16x16x32_bf16 v[44:47], v[52:55], v[104:107], v[44:47]
    v_mfma_f32_16x16x32_bf16 v[44:47], v[48:51], v[108:111], v[44:47]
    s_waitcnt lgkmcnt(0)
    v_mfma_f32_16x16x32_bf16 v[16:19], v[112:115], v[144:147], v[16:19]
    v_mfma_f32_16x16x32_bf16 v[20:23], v[116:119], v[144:147], v[20:23]
    v_mfma_f32_16x16x32_bf16 v[24:27], v[120:123], v[144:147], v[24:27]
    v_mfma_f32_16x16x32_bf16 v[28:31], v[124:127], v[144:147], v[28:31]
    s_movk_i32 s6, 0x6000
    buffer_load_dwordx4 v[236:239], v5, s[88:91], s6 offen offset:3072 sc1
    v_mfma_f32_16x16x32_bf16 v[32:35], v[128:131], v[144:147], v[32:35]
    v_mfma_f32_16x16x32_bf16 v[36:39], v[132:135], v[144:147], v[36:39]
    v_mfma_f32_16x16x32_bf16 v[40:43], v[136:139], v[144:147], v[40:43]
    v_mfma_f32_16x16x32_bf16 v[44:47], v[140:143], v[144:147], v[44:47]
    v_mfma_f32_16x16x32_bf16 v[20:23], v[112:115], v[148:151], v[20:23]
    v_mfma_f32_16x16x32_bf16 v[24:27], v[116:119], v[148:151], v[24:27]
    v_mfma_f32_16x16x32_bf16 v[28:31], v[120:123], v[148:151], v[28:31]
    s_movk_i32 s6, 0x7000
    buffer_load_dwordx4 v[240:243], v5, s[88:91], s6 offen offset:0 sc1
    v_mfma_f32_16x16x32_bf16 v[32:35], v[124:127], v[148:151], v[32:35]
    v_mfma_f32_16x16x32_bf16 v[36:39], v[128:131], v[148:151], v[36:39]
    v_mfma_f32_16x16x32_bf16 v[40:43], v[132:135], v[148:151], v[40:43]
    v_mfma_f32_16x16x32_bf16 v[44:47], v[136:139], v[148:151], v[44:47]
    v_mfma_f32_16x16x32_bf16 v[24:27], v[112:115], v[152:155], v[24:27]
    v_mfma_f32_16x16x32_bf16 v[28:31], v[116:119], v[152:155], v[28:31]
    v_mfma_f32_16x16x32_bf16 v[32:35], v[120:123], v[152:155], v[32:35]
    s_movk_i32 s6, 0x7000
    buffer_load_dwordx4 v[244:247], v5, s[88:91], s6 offen offset:1024 sc1
    v_mfma_f32_16x16x32_bf16 v[36:39], v[124:127], v[152:155], v[36:39]
    v_mfma_f32_16x16x32_bf16 v[40:43], v[128:131], v[152:155], v[40:43]
    v_mfma_f32_16x16x32_bf16 v[44:47], v[132:135], v[152:155], v[44:47]
    v_mfma_f32_16x16x32_bf16 v[28:31], v[112:115], v[156:159], v[28:31]
    v_mfma_f32_16x16x32_bf16 v[32:35], v[116:119], v[156:159], v[32:35]
    v_mfma_f32_16x16x32_bf16 v[36:39], v[120:123], v[156:159], v[36:39]
    v_mfma_f32_16x16x32_bf16 v[40:43], v[124:127], v[156:159], v[40:43]
    s_movk_i32 s6, 0x7000
    buffer_load_dwordx4 v[248:251], v5, s[88:91], s6 offen offset:2048 sc1
    v_mfma_f32_16x16x32_bf16 v[44:47], v[128:131], v[156:159], v[44:47]
    v_mfma_f32_16x16x32_bf16 v[32:35], v[112:115], v[160:163], v[32:35]
    v_mfma_f32_16x16x32_bf16 v[36:39], v[116:119], v[160:163], v[36:39]
    v_mfma_f32_16x16x32_bf16 v[40:43], v[120:123], v[160:163], v[40:43]
    v_mfma_f32_16x16x32_bf16 v[44:47], v[124:127], v[160:163], v[44:47]
    v_mfma_f32_16x16x32_bf16 v[36:39], v[112:115], v[164:167], v[36:39]
    v_mfma_f32_16x16x32_bf16 v[40:43], v[116:119], v[164:167], v[40:43]
    s_movk_i32 s6, 0x7000
    buffer_load_dwordx4 v[252:255], v5, s[88:91], s6 offen offset:3072 sc1
    v_mfma_f32_16x16x32_bf16 v[44:47], v[120:123], v[164:167], v[44:47]
    v_mfma_f32_16x16x32_bf16 v[40:43], v[112:115], v[168:171], v[40:43]
    v_mfma_f32_16x16x32_bf16 v[44:47], v[116:119], v[168:171], v[44:47]
    v_mfma_f32_16x16x32_bf16 v[44:47], v[112:115], v[172:175], v[44:47]
    s_setprio 2
    s_lshl_b32 s5, s3, 13
    s_add_u32 s5, s5, 48640
    v_add_u32 v10, s5, v5
    s_lshl_b32 s7, s3, 11
    s_add_u32 s7, s7, 48640
    v_add_u32 v11, s7, v5
    s_mul_i32 s5, s3, 3584
    s_add_u32 s5, s5, s15
    s_lshl_b32 s5, s5, 7
    s_add_u32 s13, s5, 0x400000
    v_lshrrev_b32 v12, 5, v1
    v_mul_u32_u24 v12, 114688, v12
    v_and_b32 v13, 31, v1
    v_lshl_add_u32 v12, v13, 2, v12
    ds_write_b128 v10, v[16:19] offset:0
    ds_write_b128 v10, v[20:23] offset:1024
    ds_write_b128 v10, v[24:27] offset:2048
    ds_write_b128 v10, v[28:31] offset:3072
    ds_write_b128 v10, v[32:35] offset:4096
    ds_write_b128 v10, v[36:39] offset:5120
    ds_write_b128 v10, v[40:43] offset:6144
    ds_write_b128 v10, v[44:47] offset:7168
    buffer_load_dwordx4 v[128:131], v5, s[88:91], 0 offen offset:0 sc1
    buffer_load_dwordx4 v[132:135], v5, s[88:91], 0 offen offset:1024 sc1
    buffer_load_dwordx4 v[136:139], v5, s[88:91], 0 offen offset:2048 sc1
    buffer_load_dwordx4 v[140:143], v5, s[88:91], 0 offen offset:3072 sc1
    s_movk_i32 s6, 0x1000
    buffer_load_dwordx4 v[144:147], v5, s[88:91], s6 offen offset:0 sc1
    s_movk_i32 s6, 0x1000
    buffer_load_dwordx4 v[148:151], v5, s[88:91], s6 offen offset:1024 sc1
    s_movk_i32 s6, 0x1000
    buffer_load_dwordx4 v[152:155], v5, s[88:91], s6 offen offset:2048 sc1
    s_movk_i32 s6, 0x1000
    buffer_load_dwordx4 v[156:159], v5, s[88:91], s6 offen offset:3072 sc1
    s_movk_i32 s6, 0x2000
    buffer_load_dwordx4 v[160:163], v5, s[88:91], s6 offen offset:0 sc1
    s_movk_i32 s6, 0x2000
    buffer_load_dwordx4 v[164:167], v5, s[88:91], s6 offen offset:1024 sc1
    s_movk_i32 s6, 0x2000
    buffer_load_dwordx4 v[168:171], v5, s[88:91], s6 offen offset:2048 sc1
    s_movk_i32 s6, 0x2000
    buffer_load_dwordx4 v[172:175], v5, s[88:91], s6 offen offset:3072 sc1
    s_waitcnt lgkmcnt(0)
    s_barrier
    ds_read_b128 v[48:51], v11 offset:0
    ds_read_b128 v[52:55], v11 offset:1024
    ds_read_b128 v[56:59], v11 offset:8192
    ds_read_b128 v[60:63], v11 offset:9216
    ds_read_b128 v[64:67], v11 offset:16384
    ds_read_b128 v[68:71], v11 offset:17408
    ds_read_b128 v[72:75], v11 offset:24576
    ds_read_b128 v[76:79], v11 offset:25600
    s_lshl_b32 s7, s15, 2
    s_add_u32 s7, s7, s3
    s_lshl_b32 s7, s7, 7
    s_add_u32 s7, s7, 0x3000c
    s_waitcnt lgkmcnt(0)
    v_pk_add_f32 v[48:49], v[48:49], v[56:57]
    v_pk_add_f32 v[64:65], v[64:65], v[72:73]
    v_pk_add_f32 v[50:51], v[50:51], v[58:59]
    v_pk_add_f32 v[66:67], v[66:67], v[74:75]
    v_pk_add_f32 v[52:53], v[52:53], v[60:61]
    v_pk_add_f32 v[68:69], v[68:69], v[76:77]
    v_pk_add_f32 v[54:55], v[54:55], v[62:63]
    v_pk_add_f32 v[70:71], v[70:71], v[78:79]
    v_cvt_pk_bf16_f32 v80, v48, v64
    v_cvt_pk_bf16_f32 v81, v49, v65
    v_cvt_pk_bf16_f32 v82, v50, v66
    v_cvt_pk_bf16_f32 v83, v51, v67
    v_cvt_pk_bf16_f32 v84, v52, v68
    v_cvt_pk_bf16_f32 v85, v53, v69
    v_cvt_pk_bf16_f32 v86, v54, v70
    v_cvt_pk_bf16_f32 v87, v55, v71
    v_permlane16_swap_b32 v80, v81
    v_permlane16_swap_b32 v82, v83
    v_permlane16_swap_b32 v84, v85
    v_permlane16_swap_b32 v86, v87
    buffer_store_dword v80, v12, s[56:59], s13 offen sc1
    s_add_u32 s13, s13, 28672
    buffer_store_dword v82, v12, s[56:59], s13 offen sc1
    s_add_u32 s13, s13, 28672
    buffer_store_dword v81, v12, s[56:59], s13 offen sc1
    s_add_u32 s13, s13, 28672
    buffer_store_dword v83, v12, s[56:59], s13 offen sc1
    s_add_u32 s13, s13, 143360
    buffer_store_dword v84, v12, s[56:59], s13 offen sc1
    s_add_u32 s13, s13, 28672
    buffer_store_dword v86, v12, s[56:59], s13 offen sc1
    s_add_u32 s13, s13, 28672
    buffer_store_dword v85, v12, s[56:59], s13 offen sc1
    s_add_u32 s13, s13, 28672
    buffer_store_dword v87, v12, s[56:59], s13 offen sc1
    s_waitcnt vmcnt(0)
    v_mov_b32 v13, s4
    s_mov_b32 exec_lo, 1
    s_mov_b32 exec_hi, 0
    buffer_store_dword v13, off, s[56:59], s7 sc1
    s_mov_b64 exec, -1
    s_cmp_lg_u32 s87, 0
    s_cbranch_scc1 L_s_wo
L_s_wfb:
    v_and_b32 v13, 7, v1
    v_lshlrev_b32 v13, 7, v13
    v_add_u32 v13, s86, v13
    s_mov_b32 s5, 0
L_poll_w:
    buffer_load_dword v14, v13, s[56:59], 0 offen sc1
    s_waitcnt vmcnt(0)
    v_cmp_ne_u32 vcc, s4, v14
    s_nop 1
    s_cmp_eq_u64 vcc, 0
    s_cbranch_scc1 L_pollok_w
    s_mov_b64 exec, vcc
    s_sleep 4
    s_add_u32 s5, s5, 1
    s_cmp_lt_u32 s5, 400000
    s_cbranch_scc1 L_poll_w
L_pollok_w:
    s_mov_b64 exec, -1
    s_mov_b32 s90, 32768
    buffer_load_dwordx4 v[128:131], v5, s[88:91], 0 offen offset:0 sc1
    buffer_load_dwordx4 v[132:135], v5, s[88:91], 0 offen offset:1024 sc1
    buffer_load_dwordx4 v[136:139], v5, s[88:91], 0 offen offset:2048 sc1
    buffer_load_dwordx4 v[140:143], v5, s[88:91], 0 offen offset:3072 sc1
    s_movk_i32 s6, 0x1000
    buffer_load_dwordx4 v[144:147], v5, s[88:91], s6 offen offset:0 sc1
    s_movk_i32 s6, 0x1000
    buffer_load_dwordx4 v[148:151], v5, s[88:91], s6 offen offset:1024 sc1
    s_movk_i32 s6, 0x1000
    buffer_load_dwordx4 v[152:155], v5, s[88:91], s6 offen offset:2048 sc1
    s_movk_i32 s6, 0x1000
    buffer_load_dwordx4 v[156:159], v5, s[88:91], s6 offen offset:3072 sc1
    s_movk_i32 s6, 0x2000
    buffer_load_dwordx4 v[160:163], v5, s[88:91], s6 offen offset:0 sc1
    s_movk_i32 s6, 0x2000
    buffer_load_dwordx4 v[164:167], v5, s[88:91], s6 offen offset:1024 sc1
    s_movk_i32 s6, 0x2000
    buffer_load_dwordx4 v[168:171], v5, s[88:91], s6 offen offset:2048 sc1
    s_movk_i32 s6, 0x2000
    buffer_load_dwordx4 v[172:175], v5, s[88:91], s6 offen offset:3072 sc1
    s_movk_i32 s6, 0x3000
    buffer_load_dwordx4 v[176:179], v5, s[88:91], s6 offen offset:0 sc1
    s_movk_i32 s6, 0x3000
    buffer_load_dwordx4 v[180:183], v5, s[88:91], s6 offen offset:1024 sc1
    s_movk_i32 s6, 0x3000
    buffer_load_dwordx4 v[184:187], v5, s[88:91], s6 offen offset:2048 sc1
    s_movk_i32 s6, 0x3000
    buffer_load_dwordx4 v[188:191], v5, s[88:91], s6 offen offset:3072 sc1
    s_movk_i32 s6, 0x4000
    buffer_load_dwordx4 v[192:195], v5, s[88:91], s6 offen offset:0 sc1
    s_movk_i32 s6, 0x4000
    buffer_load_dwordx4 v[196:199], v5, s[88:91], s6 offen offset:1024 sc1
    s_movk_i32 s6, 0x4000
    buffer_load_dwordx4 v[200:203], v5, s[88:91], s6 offen offset:2048 sc1
    s_movk_i32 s6, 0x4000
    buffer_load_dwordx4 v[204:207], v5, s[88:91], s6 offen offset:3072 sc1
    s_movk_i32 s6, 0x5000
    buffer_load_dwordx4 v[208:211], v5, s[88:91], s6 offen offset:0 sc1
    s_movk_i32 s6, 0x5000
    buffer_load_dwordx4 v[212:215], v5, s[88:91], s6 offen offset:1024 sc1
    s_movk_i32 s6, 0x5000
    buffer_load_dwordx4 v[216:219], v5, s[88:91], s6 offen offset:2048 sc1
    s_movk_i32 s6, 0x5000
    buffer_load_dwordx4 v[220:223], v5, s[88:91], s6 offen offset:3072 sc1
    s_movk_i32 s6, 0x6000
    buffer_load_dwordx4 v[224:227], v5, s[88:91], s6 offen offset:0 sc1
    s_movk_i32 s6, 0x6000
    buffer_load_dwordx4 v[228:231], v5, s[88:91], s6 offen offset:1024 sc1
    s_movk_i32 s6, 0x6000
    buffer_load_dwordx4 v[232:235], v5, s[88:91], s6 offen offset:2048 sc1
    s_movk_i32 s6, 0x6000
    buffer_load_dwordx4 v[236:239], v5, s[88:91], s6 offen offset:3072 sc1
    s_movk_i32 s6, 0x7000
    buffer_load_dwordx4 v[240:243], v5, s[88:91], s6 offen offset:0 sc1
    s_movk_i32 s6, 0x7000
    buffer_load_dwordx4 v[244:247], v5, s[88:91], s6 offen offset:1024 sc1
    s_movk_i32 s6, 0x7000
    buffer_load_dwordx4 v[248:251], v5, s[88:91], s6 offen offset:2048 sc1
    s_movk_i32 s6, 0x7000
    buffer_load_dwordx4 v[252:255], v5, s[88:91], s6 offen offset:3072 sc1
L_s_wo:
    s_mov_b32 s68, s46
    s_mov_b32 s69, s47
    s_mov_b32 s70, 0x1c0000
    s_mov_b32 s71, 0x20000
    s_lshl_b32 s5, s11, 4
    s_lshl_b32 s6, s3, 2
    s_add_u32 s5, s5, s6
    s_lshl_b32 s80, s5, 11
    s_add_u32 s80, s80, 0x200000
    s_add_u32 s81, s80, 4096
    s_lshl_b32 s5, s5, 7
    s_add_u32 s5, s5, 0x1000c
    v_and_b32 v13, 3, v1
    v_lshlrev_b32 v16, 7, v13
    v_bfe_u32 v13, v1, 2, 1
    v_mul_u32_u24 v13, 0x70000, v13
    v_add3_u32 v11, s5, v16, v13
    s_lshl_b32 s5, s3, 13
    v_add_u32 v20, s5, v5
    v_and_b32 v14, 31, v1
    v_lshrrev_b32 v15, 5, v1
    v_mul_u32_u24 v12, 896, v14
    v_lshl_add_u32 v12, v15, 4, v12
    s_mul_i32 s74, s11, 28672
    s_lshl_b32 s5, s12, 8
    s_add_u32 s74, s74, s5
    s_lshl_b32 s5, s85, 6
    s_add_u32 s74, s74, s5
    s_lshr_b32 s75, s4, 16
    s_and_b32 s75, s75, 0xbfff
    s_lshl_b32 s87, s12, 6
    s_lshl_b32 s5, s85, 4
    s_add_u32 s87, s87, s5
    s_lshr_b32 s5, s11, 4
    s_lshl_b32 s6, s87, 2
    s_add_u32 s5, s5, s6
    s_lshl_b32 s5, s5, 7
    s_add_u32 s5, s5, 0x3000c
    v_and_b32 v13, 15, v1
    v_lshlrev_b32 v13, 9, v13
    v_add_u32 v21, s5, v13
    v_lshlrev_b32 v16, 8, v15
    v_lshl_add_u32 v16, v14, 2, v16
    v_lshlrev_b32 v17, 3, v14
    s_mul_i32 s5, s11, 224
    s_add_u32 s87, s5, s87
    s_lshl_b32 s87, s87, 7
    s_add_u32 s87, s87, 0x400000
    s_lshl_b32 s15, s11, 8
    s_add_u32 s15, s15, 0x60000
    s_mov_b32 s5, 0
L_poll_b:
    buffer_load_dword v14, v21, s[56:59], 0 offen sc1
    s_waitcnt vmcnt(0)
    v_cmp_ne_u32 vcc, s4, v14
    s_nop 1
    s_cmp_eq_u64 vcc, 0
    s_cbranch_scc1 L_pollok_b
    s_mov_b64 exec, vcc
    s_sleep 12
    s_add_u32 s5, s5, 1
    s_cmp_lt_u32 s5, 400000
    s_cbranch_scc1 L_poll_b
L_pollok_b:
    s_mov_b64 exec, -1
    buffer_load_dword v24, v16, s[56:59], s87 offen offset:0 sc1
    buffer_load_dword v25, v16, s[56:59], s87 offen offset:128 sc1
    buffer_load_dword v26, v16, s[56:59], s87 offen offset:512 sc1
    buffer_load_dword v27, v16, s[56:59], s87 offen offset:640 sc1
    buffer_load_dword v28, v16, s[56:59], s87 offen offset:1024 sc1
    buffer_load_dword v29, v16, s[56:59], s87 offen offset:1152 sc1
    buffer_load_dword v30, v16, s[56:59], s87 offen offset:1536 sc1
    buffer_load_dword v31, v16, s[56:59], s87 offen offset:1664 sc1
    buffer_load_dwordx2 v[18:19], v17, s[56:59], s15 offen sc1
    s_mov_b32 s5, 0
    s_branch L_s_g1w
L_s_g1:
    buffer_load_dwordx2 v[18:19], v17, s[56:59], s15 offen sc1
L_s_g1w:
    s_waitcnt vmcnt(0)
    v_cmp_ne_u32 vcc, s4, v19
    s_nop 1
    s_cmp_eq_u64 vcc, 0
    s_cbranch_scc1 L_s_g1ok
    s_add_u32 s5, s5, 1
    s_cmp_lt_u32 s5, 400000
    s_cbranch_scc1 L_s_g1
L_s_g1ok:
    v_lshlrev_b32 v64, 16, v24
    v_and_b32 v65, 0xffff0000, v24
    v_lshlrev_b32 v66, 16, v25
    v_and_b32 v67, 0xffff0000, v25
    v_lshlrev_b32 v68, 16, v26
    v_and_b32 v69, 0xffff0000, v26
    v_lshlrev_b32 v70, 16, v27
    v_and_b32 v71, 0xffff0000, v27
    v_lshlrev_b32 v72, 16, v28
    v_and_b32 v73, 0xffff0000, v28
    v_lshlrev_b32 v74, 16, v29
    v_and_b32 v75, 0xffff0000, v29
    v_lshlrev_b32 v76, 16, v30
    v_and_b32 v77, 0xffff0000, v30
    v_lshlrev_b32 v78, 16, v31
    v_and_b32 v79, 0xffff0000, v31
    v_pk_mul_f32 v[64:65], v[64:65], v[18:19] op_sel_hi:[1,0]
    v_pk_mul_f32 v[66:67], v[66:67], v[18:19] op_sel_hi:[1,0]
    v_pk_mul_f32 v[68:69], v[68:69], v[18:19] op_sel_hi:[1,0]
    v_pk_mul_f32 v[70:71], v[70:71], v[18:19] op_sel_hi:[1,0]
    v_pk_mul_f32 v[72:73], v[72:73], v[18:19] op_sel_hi:[1,0]
    v_pk_mul_f32 v[74:75], v[74:75], v[18:19] op_sel_hi:[1,0]
    v_pk_mul_f32 v[76:77], v[76:77], v[18:19] op_sel_hi:[1,0]
    v_pk_mul_f32 v[78:79], v[78:79], v[18:19] op_sel_hi:[1,0]
    v_not_b32 v14, s4
    s_setprio 0
    s_mov_b32 s76, 0
    s_mov_b32 s77, 0
    s_mov_b32 s79, 0
    s_mov_b32 s84, 0
    s_mov_b32 s15, 0
L_or:
    s_bcnt1_i32_b32 s5, s76
    s_cmp_ge_u32 s5, 2
    s_cselect_b32 s5, 15, s76
    s_andn2_b32 s78, s5, s77
    s_cbranch_scc0 L_ol3
    s_bitcmp1_b32 s78, 0
    s_cbranch_scc0 L_ol0
    s_bitcmp1_b32 s84, 0
    s_cselect_b32 s5, 0x700000, 0
    s_add_u32 s5, s5, s80
    buffer_load_dwordx4 v[32:35], v5, s[56:59], s5 offen offset:0 sc1
    buffer_load_dwordx4 v[36:39], v5, s[56:59], s5 offen offset:1024 sc1
L_ol0:
    s_bitcmp1_b32 s78, 1
    s_cbranch_scc0 L_ol1
    s_bitcmp1_b32 s84, 1
    s_cselect_b32 s5, 0x700000, 0
    s_add_u32 s5, s5, s80
    buffer_load_dwordx4 v[40:43], v5, s[56:59], s5 offen offset:2048 sc1
    buffer_load_dwordx4 v[44:47], v5, s[56:59], s5 offen offset:3072 sc1
L_ol1:
    s_bitcmp1_b32 s78, 2
    s_cbranch_scc0 L_ol2
    s_bitcmp1_b32 s84, 2
    s_cselect_b32 s5, 0x700000, 0
    s_add_u32 s5, s5, s81
    buffer_load_dwordx4 v[48:51], v5, s[56:59], s5 offen offset:0 sc1
    buffer_load_dwordx4 v[52:55], v5, s[56:59], s5 offen offset:1024 sc1
L_ol2:
    s_bitcmp1_b32 s78, 3
    s_cbranch_scc0 L_ol3
    s_bitcmp1_b32 s84, 3
    s_cselect_b32 s5, 0x700000, 0
    s_add_u32 s5, s5, s81
    buffer_load_dwordx4 v[56:59], v5, s[56:59], s5 offen offset:2048 sc1
    buffer_load_dwordx4 v[60:63], v5, s[56:59], s5 offen offset:3072 sc1
L_ol3:
    s_and_b32 s5, s15, 7
    s_cmp_eq_u32 s5, 7
    s_cselect_b32 exec_lo, 0xff, 15
    s_mov_b32 exec_hi, 0
    buffer_load_dword v14, v11, s[56:59], 0 offen sc1
    s_mov_b64 exec, -1
    s_cmp_eq_u32 s78, 0
    s_waitcnt vmcnt(0)
    v_cmp_eq_u32 vcc, s4, v14
    s_nop 1
    s_mov_b32 s76, vcc_lo
    s_cbranch_scc1 L_oc3
    s_bitcmp1_b32 s78, 0
    s_cbranch_scc0 L_oc0
    v_cmp_ne_u32_sdwa vcc, v35, s75 src0_sel:WORD_1 src1_sel:DWORD
    v_cmp_ne_u32_sdwa s[6:7], v39, s75 src0_sel:WORD_1 src1_sel:DWORD
    s_nop 1
    s_or_b64 vcc, vcc, s[6:7]
    s_cbranch_scc1 L_oc0
    ds_write_b128 v20, v[32:35] offset:0
    ds_write_b128 v20, v[36:39] offset:1024
    s_bitset1_b32 s77, 0
L_oc0:
    s_bitcmp1_b32 s78, 1
    s_cbranch_scc0 L_oc1
    v_cmp_ne_u32_sdwa vcc, v43, s75 src0_sel:WORD_1 src1_sel:DWORD
    v_cmp_ne_u32_sdwa s[6:7], v47, s75 src0_sel:WORD_1 src1_sel:DWORD
    s_nop 1
    s_or_b64 vcc, vcc, s[6:7]
    s_cbranch_scc1 L_oc1
    ds_write_b128 v20, v[40:43] offset:2048
    ds_write_b128 v20, v[44:47] offset:3072
    s_bitset1_b32 s77, 1
L_oc1:
    s_bitcmp1_b32 s78, 2
    s_cbranch_scc0 L_oc2
    v_cmp_ne_u32_sdwa vcc, v51, s75 src0_sel:WORD_1 src1_sel:DWORD
    v_cmp_ne_u32_sdwa s[6:7], v55, s75 src0_sel:WORD_1 src1_sel:DWORD
    s_nop 1
    s_or_b64 vcc, vcc, s[6:7]
    s_cbranch_scc1 L_oc2
    ds_write_b128 v20, v[48:51] offset:4096
    ds_write_b128 v20, v[52:55] offset:5120
    s_bitset1_b32 s77, 2
L_oc2:
    s_bitcmp1_b32 s78, 3
    s_cbranch_scc0 L_oc3
    v_cmp_ne_u32_sdwa vcc, v59, s75 src0_sel:WORD_1 src1_sel:DWORD
    v_cmp_ne_u32_sdwa s[6:7], v63, s75 src0_sel:WORD_1 src1_sel:DWORD
    s_nop 1
    s_or_b64 vcc, vcc, s[6:7]
    s_cbranch_scc1 L_oc3
    ds_write_b128 v20, v[56:59] offset:6144
    ds_write_b128 v20, v[60:63] offset:7168
    s_bitset1_b32 s77, 3
L_oc3:
    s_andn2_b32 s5, s78, s77
    s_or_b32 s79, s79, s5
    s_lshr_b32 s6, s76, 4
    s_orn2_b32 s5, s79, s76
    s_and_b32 s84, s6, s5
    s_or_b32 s76, s76, s6
    s_and_b32 s76, s76, 15
    s_cmp_eq_u32 s77, 15
    s_cbranch_scc1 L_od
    s_andn2_b32 s5, s76, s77
    s_cbranch_scc1 L_ob
    s_sleep 2
L_ob:
    s_add_u32 s15, s15, 1
    s_cmp_lt_u32 s15, 400000
    s_cbranch_scc1 L_or
L_od:
    s_setprio 3
    s_waitcnt lgkmcnt(0)
    s_barrier
    s_cmp_lg_u32 s3, s85
    s_cbranch_scc1 L_s_fin
    ds_read_b128 v[80:83], v5 offset:0
    ds_read_b128 v[84:87], v5 offset:1024
    ds_read_b128 v[88:91], v5 offset:2048
    ds_read_b128 v[92:95], v5 offset:3072
    ds_read_b128 v[96:99], v5 offset:4096
    ds_read_b128 v[100:103], v5 offset:5120
    ds_read_b128 v[104:107], v5 offset:6144
    ds_read_b128 v[108:111], v5 offset:7168
    s_waitcnt lgkmcnt(7)
    v_mfma_f32_32x32x16_bf16 v[64:79], v[128:131], v[80:83], v[64:79]
    ds_read_b128 v[80:83], v5 offset:8192
    s_waitcnt lgkmcnt(7)
    v_mfma_f32_32x32x16_bf16 v[64:79], v[132:135], v[84:87], v[64:79]
    ds_read_b128 v[84:87], v5 offset:9216
    s_waitcnt lgkmcnt(7)
    v_mfma_f32_32x32x16_bf16 v[64:79], v[136:139], v[88:91], v[64:79]
    ds_read_b128 v[88:91], v5 offset:10240
    s_waitcnt lgkmcnt(7)
    v_mfma_f32_32x32x16_bf16 v[64:79], v[140:143], v[92:95], v[64:79]
    ds_read_b128 v[92:95], v5 offset:11264
    s_waitcnt lgkmcnt(7)
    v_mfma_f32_32x32x16_bf16 v[64:79], v[144:147], v[96:99], v[64:79]
    ds_read_b128 v[96:99], v5 offset:12288
    s_waitcnt lgkmcnt(7)
    v_mfma_f32_32x32x16_bf16 v[64:79], v[148:151], v[100:103], v[64:79]
    ds_read_b128 v[100:103], v5 offset:13312
    s_waitcnt lgkmcnt(7)
    v_mfma_f32_32x32x16_bf16 v[64:79], v[152:155], v[104:107], v[64:79]
    ds_read_b128 v[104:107], v5 offset:14336
    s_waitcnt lgkmcnt(7)
    v_mfma_f32_32x32x16_bf16 v[64:79], v[156:159], v[108:111], v[64:79]
    ds_read_b128 v[108:111], v5 offset:15360
    s_waitcnt lgkmcnt(7)
    v_mfma_f32_32x32x16_bf16 v[64:79], v[160:163], v[80:83], v[64:79]
    ds_read_b128 v[80:83], v5 offset:16384
    s_waitcnt lgkmcnt(7)
    v_mfma_f32_32x32x16_bf16 v[64:79], v[164:167], v[84:87], v[64:79]
    ds_read_b128 v[84:87], v5 offset:17408
    s_waitcnt lgkmcnt(7)
    v_mfma_f32_32x32x16_bf16 v[64:79], v[168:171], v[88:91], v[64:79]
    ds_read_b128 v[88:91], v5 offset:18432
    s_waitcnt lgkmcnt(7)
    v_mfma_f32_32x32x16_bf16 v[64:79], v[172:175], v[92:95], v[64:79]
    ds_read_b128 v[92:95], v5 offset:19456
    s_waitcnt lgkmcnt(7)
    v_mfma_f32_32x32x16_bf16 v[64:79], v[176:179], v[96:99], v[64:79]
    ds_read_b128 v[96:99], v5 offset:20480
    s_waitcnt lgkmcnt(7)
    v_mfma_f32_32x32x16_bf16 v[64:79], v[180:183], v[100:103], v[64:79]
    ds_read_b128 v[100:103], v5 offset:21504
    s_waitcnt lgkmcnt(7)
    v_mfma_f32_32x32x16_bf16 v[64:79], v[184:187], v[104:107], v[64:79]
    ds_read_b128 v[104:107], v5 offset:22528
    s_waitcnt lgkmcnt(7)
    v_mfma_f32_32x32x16_bf16 v[64:79], v[188:191], v[108:111], v[64:79]
    ds_read_b128 v[108:111], v5 offset:23552
    s_waitcnt lgkmcnt(7)
    v_mfma_f32_32x32x16_bf16 v[64:79], v[192:195], v[80:83], v[64:79]
    ds_read_b128 v[80:83], v5 offset:24576
    s_waitcnt lgkmcnt(7)
    v_mfma_f32_32x32x16_bf16 v[64:79], v[196:199], v[84:87], v[64:79]
    ds_read_b128 v[84:87], v5 offset:25600
    s_waitcnt lgkmcnt(7)
    v_mfma_f32_32x32x16_bf16 v[64:79], v[200:203], v[88:91], v[64:79]
    ds_read_b128 v[88:91], v5 offset:26624
    s_waitcnt lgkmcnt(7)
    v_mfma_f32_32x32x16_bf16 v[64:79], v[204:207], v[92:95], v[64:79]
    ds_read_b128 v[92:95], v5 offset:27648
    s_waitcnt lgkmcnt(7)
    v_mfma_f32_32x32x16_bf16 v[64:79], v[208:211], v[96:99], v[64:79]
    ds_read_b128 v[96:99], v5 offset:28672
    s_waitcnt lgkmcnt(7)
    v_mfma_f32_32x32x16_bf16 v[64:79], v[212:215], v[100:103], v[64:79]
    ds_read_b128 v[100:103], v5 offset:29696
    s_waitcnt lgkmcnt(7)
    v_mfma_f32_32x32x16_bf16 v[64:79], v[216:219], v[104:107], v[64:79]
    ds_read_b128 v[104:107], v5 offset:30720
    s_waitcnt lgkmcnt(7)
    v_mfma_f32_32x32x16_bf16 v[64:79], v[220:223], v[108:111], v[64:79]
    ds_read_b128 v[108:111], v5 offset:31744
    s_waitcnt lgkmcnt(7)
    v_mfma_f32_32x32x16_bf16 v[64:79], v[224:227], v[80:83], v[64:79]
    s_waitcnt lgkmcnt(6)
    v_mfma_f32_32x32x16_bf16 v[64:79], v[228:231], v[84:87], v[64:79]
    s_waitcnt lgkmcnt(5)
    v_mfma_f32_32x32x16_bf16 v[64:79], v[232:235], v[88:91], v[64:79]
    s_waitcnt lgkmcnt(4)
    v_mfma_f32_32x32x16_bf16 v[64:79], v[236:239], v[92:95], v[64:79]
    s_waitcnt lgkmcnt(3)
    v_mfma_f32_32x32x16_bf16 v[64:79], v[240:243], v[96:99], v[64:79]
    s_waitcnt lgkmcnt(2)
    v_mfma_f32_32x32x16_bf16 v[64:79], v[244:247], v[100:103], v[64:79]
    s_waitcnt lgkmcnt(1)
    v_mfma_f32_32x32x16_bf16 v[64:79], v[248:251], v[104:107], v[64:79]
    s_waitcnt lgkmcnt(0)
    v_mfma_f32_32x32x16_bf16 v[64:79], v[252:255], v[108:111], v[64:79]
    s_nop 11
    v_cvt_pk_bf16_f32 v48, v64, v65
    v_cvt_pk_bf16_f32 v49, v66, v67
    v_cvt_pk_bf16_f32 v50, v68, v69
    v_cvt_pk_bf16_f32 v51, v70, v71
    v_cvt_pk_bf16_f32 v52, v72, v73
    v_cvt_pk_bf16_f32 v53, v74, v75
    v_cvt_pk_bf16_f32 v54, v76, v77
    v_cvt_pk_bf16_f32 v55, v78, v79
    v_permlane32_swap_b32 v48, v50
    v_permlane32_swap_b32 v49, v51
    v_permlane32_swap_b32 v52, v54
    v_permlane32_swap_b32 v53, v55
    buffer_store_dwordx4 v[48:51], v12, s[68:71], s74 offen
    buffer_store_dwordx4 v[52:55], v12, s[68:71], s74 offen offset:32
L_s_fin:
L_end:
    s_endpgm
L_roleA:
    s_and_b32 s5, s2, 7
    s_bfe_u32 s6, s2, 0x50003
    s_lshr_b32 s7, s6, 4
    s_lshl_b32 s5, s5, 1
    s_add_u32 s5, s5, s7
    s_and_b32 s8, s6, 15
    s_lshl_b32 s9, s5, 2
    s_add_u32 s9, s9, s3
    s_mul_i32 s10, s9, 28672
    s_add_u32 s11, s10, 14336
    s_setprio 0
    v_bfe_u32 v13, v1, 2, 3
    v_mul_u32_u24 v2, 3584, v13
    v_and_b32 v14, 3, v1
    v_lshl_add_u32 v2, v14, 4, v2
    v_lshrrev_b32 v13, 5, v1
    v_lshl_add_u32 v2, v13, 6, v2
    v_lshrrev_b32 v13, 2, v1
    v_mul_u32_u24 v6, 896, v13
    v_lshl_add_u32 v6, v14, 4, v6
    v_lshlrev_b32 v8, 1, v1
    s_mul_i32 s12, s3, 100352
    s_mul_i32 s13, s8, 56
    s_add_u32 s12, s12, s13
    s_mul_i32 s13, s3, 7168
    s_mul_i32 s14, s3, 224
    s_mov_b32 m0, s13
    s_waitcnt lgkmcnt(0)
    s_load_dword s4, s[48:49], 12
    s_mov_b32 s52, s16
    s_mov_b32 s53, s17
    s_mov_b32 s54, 0x1c0000
    s_mov_b32 s55, 0x20000
    s_mov_b32 s60, s18
    s_mov_b32 s61, s19
    s_mov_b32 s62, 0x62000
    s_mov_b32 s63, 0x20000
    buffer_load_dwordx4 v6, s[60:63], s12 offen lds
    s_add_u32 m0, m0, 1024
    s_add_u32 s12, s12, 14336
    buffer_load_dwordx4 v6, s[60:63], s12 offen lds
    s_add_u32 m0, m0, 1024
    s_add_u32 s12, s12, 14336
    buffer_load_dwordx4 v6, s[60:63], s12 offen lds
    s_add_u32 m0, m0, 1024
    s_add_u32 s12, s12, 14336
    buffer_load_dwordx4 v6, s[60:63], s12 offen lds
    s_add_u32 m0, m0, 1024
    s_add_u32 s12, s12, 14336
    buffer_load_dwordx4 v6, s[60:63], s12 offen lds
    s_add_u32 m0, m0, 1024
    s_add_u32 s12, s12, 14336
    buffer_load_dwordx4 v6, s[60:63], s12 offen lds
    s_add_u32 m0, m0, 1024
    s_add_u32 s12, s12, 14336
    buffer_load_dwordx4 v6, s[60:63], s12 offen lds
    s_mov_b32 s64, s44
    s_mov_b32 s65, s45
    s_mov_b32 s66, 0x380
    s_mov_b32 s67, 0x20000
    buffer_load_ushort v11, v8, s[64:67], s14 offen
    buffer_load_ushort v12, v8, s[64:67], s14 offen offset:128
    s_barrier
    buffer_load_dwordx4 v[128:131], v2, s[52:55], s10 offen offset:0
    buffer_load_dwordx4 v[132:135], v2, s[52:55], s10 offen offset:896
    buffer_load_dwordx4 v[136:139], v2, s[52:55], s10 offen offset:1792
    buffer_load_dwordx4 v[140:143], v2, s[52:55], s10 offen offset:2688
    buffer_load_dwordx4 v[144:147], v2, s[52:55], s10 offen offset:128
    buffer_load_dwordx4 v[148:151], v2, s[52:55], s10 offen offset:1024
    buffer_load_dwordx4 v[152:155], v2, s[52:55], s10 offen offset:1920
    buffer_load_dwordx4 v[156:159], v2, s[52:55], s10 offen offset:2816
    s_setprio 3
    s_mov_b32 s56, s48
    s_mov_b32 s57, s49
    s_mov_b32 s58, 0x1000000
    s_mov_b32 s59, 0x20000
    v_lshrrev_b32 v13, 5, v1
    v_mul_u32_u24 v13, 32, v13
    v_bfe_u32 v14, v1, 2, 2
    v_add_u32 v13, v13, v14
    v_mul_u32_u24 v7, 64, v13
    v_and_b32 v13, 16, v1
    v_lshl_add_u32 v7, v13, 1, v7
    v_and_b32 v13, 3, v1
    v_lshl_add_u32 v7, v13, 3, v7
    s_and_b32 s5, s2, 7
    s_lshl_b32 s5, s5, 2
    s_add_u32 s5, s5, s3
    s_lshl_b32 s5, s5, 7
    s_add_u32 s5, s5, 0xa000c
    v_lshlrev_b32 v3, 15, v1
    v_add_u32 v3, s5, v3
    v_lshlrev_b32 v13, 6, v1
    v_add_u32 v9, s13, v13
    s_add_u32 s12, s3, 16
    s_lshl_b32 s12, s12, 16
    s_add_u32 s68, s48, s12
    s_addc_u32 s69, s49, 0
    s_mov_b32 s70, 0x10000
    s_mov_b32 s71, 0x20000
    s_mov_b32 s72, 0x55555555
    s_mov_b32 s73, 0x55555555
    s_mov_b32 s74, 0xaaaaaaaa
    s_mov_b32 s75, 0xaaaaaaaa
    s_mov_b32 s76, 0x33333333
    s_mov_b32 s77, 0x33333333
    s_mov_b32 s78, 0xcccccccc
    s_mov_b32 s79, 0xcccccccc
    s_waitcnt vmcnt(8)
    ds_write_b16 v9, v11 offset:56
    ds_write_b16 v9, v12 offset:4152
    s_waitcnt lgkmcnt(0)
    s_barrier
    s_add_u32 s4, s4, 0x9e3779b9
    ds_read_b64_tr_b16 v[16:17], v7 offset:0
    ds_read_b64_tr_b16 v[18:19], v7 offset:256
    ds_read_b64_tr_b16 v[20:21], v7 offset:512
    ds_read_b64_tr_b16 v[22:23], v7 offset:768
    ds_read_b64_tr_b16 v[24:25], v7 offset:1024
    ds_read_b64_tr_b16 v[26:27], v7 offset:1280
    ds_read_b64_tr_b16 v[28:29], v7 offset:1536
    ds_read_b64_tr_b16 v[30:31], v7 offset:1792
    buffer_load_dwordx4 v[160:163], v2, s[52:55], s10 offen offset:256
    buffer_load_dwordx4 v[164:167], v2, s[52:55], s10 offen offset:1152
    buffer_load_dwordx4 v[168:171], v2, s[52:55], s10 offen offset:2048
    buffer_load_dwordx4 v[172:175], v2, s[52:55], s10 offen offset:2944
    ds_read_b64_tr_b16 v[32:33], v7 offset:4096
    ds_read_b64_tr_b16 v[34:35], v7 offset:4352
    ds_read_b64_tr_b16 v[36:37], v7 offset:4608
    ds_read_b64_tr_b16 v[38:39], v7 offset:4864
    ds_read_b64_tr_b16 v[40:41], v7 offset:5120
    ds_read_b64_tr_b16 v[42:43], v7 offset:5376
    ds_read_b64_tr_b16 v[44:45], v7 offset:5632
    ds_read_b64_tr_b16 v[46:47], v7 offset:5888
    s_mov_b64 vcc, s[72:73]
    s_waitcnt vmcnt(8)
    v_cndmask_b32_dpp v8, v132, v128, vcc quad_perm:[1,0,3,2] row_mask:0xf bank_mask:0xf
    v_cndmask_b32_dpp v9, v133, v129, vcc quad_perm:[1,0,3,2] row_mask:0xf bank_mask:0xf
    v_cndmask_b32_dpp v10, v134, v130, vcc quad_perm:[1,0,3,2] row_mask:0xf bank_mask:0xf
    v_cndmask_b32_dpp v11, v135, v131, vcc quad_perm:[1,0,3,2] row_mask:0xf bank_mask:0xf
    v_cndmask_b32_dpp v12, v140, v136, vcc quad_perm:[1,0,3,2] row_mask:0xf bank_mask:0xf
    v_cndmask_b32_dpp v13, v141, v137, vcc quad_perm:[1,0,3,2] row_mask:0xf bank_mask:0xf
    v_cndmask_b32_dpp v14, v142, v138, vcc quad_perm:[1,0,3,2] row_mask:0xf bank_mask:0xf
    v_cndmask_b32_dpp v15, v143, v139, vcc quad_perm:[1,0,3,2] row_mask:0xf bank_mask:0xf
    s_not_b64 vcc, s[72:73]
    v_cndmask_b32_dpp v132, v128, v132, vcc quad_perm:[1,0,3,2] row_mask:0xf bank_mask:0xf
    v_cndmask_b32_dpp v133, v129, v133, vcc quad_perm:[1,0,3,2] row_mask:0xf bank_mask:0xf
    v_cndmask_b32_dpp v134, v130, v134, vcc quad_perm:[1,0,3,2] row_mask:0xf bank_mask:0xf
    v_cndmask_b32_dpp v135, v131, v135, vcc quad_perm:[1,0,3,2] row_mask:0xf bank_mask:0xf
    v_cndmask_b32_dpp v140, v136, v140, vcc quad_perm:[1,0,3,2] row_mask:0xf bank_mask:0xf
    v_cndmask_b32_dpp v141, v137, v141, vcc quad_perm:[1,0,3,2] row_mask:0xf bank_mask:0xf
    v_cndmask_b32_dpp v142, v138, v142, vcc quad_perm:[1,0,3,2] row_mask:0xf bank_mask:0xf
    v_cndmask_b32_dpp v143, v139, v143, vcc quad_perm:[1,0,3,2] row_mask:0xf bank_mask:0xf
    s_mov_b64 vcc, s[76:77]
    v_cndmask_b32_dpp v128, v12, v8, vcc quad_perm:[2,3,0,1] row_mask:0xf bank_mask:0xf
    v_cndmask_b32_dpp v129, v13, v9, vcc quad_perm:[2,3,0,1] row_mask:0xf bank_mask:0xf
    v_cndmask_b32_dpp v130, v14, v10, vcc quad_perm:[2,3,0,1] row_mask:0xf bank_mask:0xf
    v_cndmask_b32_dpp v131, v15, v11, vcc quad_perm:[2,3,0,1] row_mask:0xf bank_mask:0xf
    v_cndmask_b32_dpp v136, v140, v132, vcc quad_perm:[2,3,0,1] row_mask:0xf bank_mask:0xf
    v_cndmask_b32_dpp v137, v141, v133, vcc quad_perm:[2,3,0,1] row_mask:0xf bank_mask:0xf
    s_waitcnt lgkmcnt(8)
    v_mfma_f32_32x32x16_bf16 v[96:111], v[16:19], v[128:131], 0
    v_cndmask_b32_dpp v138, v142, v134, vcc quad_perm:[2,3,0,1] row_mask:0xf bank_mask:0xf
    v_cndmask_b32_dpp v139, v143, v135, vcc quad_perm:[2,3,0,1] row_mask:0xf bank_mask:0xf
    s_not_b64 vcc, s[76:77]
    v_cndmask_b32_dpp v12, v8, v12, vcc quad_perm:[2,3,0,1] row_mask:0xf bank_mask:0xf
    v_cndmask_b32_dpp v13, v9, v13, vcc quad_perm:[2,3,0,1] row_mask:0xf bank_mask:0xf
    v_cndmask_b32_dpp v14, v10, v14, vcc quad_perm:[2,3,0,1] row_mask:0xf bank_mask:0xf
    v_cndmask_b32_dpp v15, v11, v15, vcc quad_perm:[2,3,0,1] row_mask:0xf bank_mask:0xf
    v_cndmask_b32_dpp v140, v132, v140, vcc quad_perm:[2,3,0,1] row_mask:0xf bank_mask:0xf
    v_cndmask_b32_dpp v141, v133, v141, vcc quad_perm:[2,3,0,1] row_mask:0xf bank_mask:0xf
    v_cndmask_b32_dpp v142, v134, v142, vcc quad_perm:[2,3,0,1] row_mask:0xf bank_mask:0xf
    v_mfma_f32_32x32x16_bf16 v[96:111], v[24:27], v[12:15], v[96:111]
    v_cndmask_b32_dpp v143, v135, v143, vcc quad_perm:[2,3,0,1] row_mask:0xf bank_mask:0xf
    buffer_load_dwordx4 v[176:179], v2, s[52:55], s10 offen offset:384
    buffer_load_dwordx4 v[180:183], v2, s[52:55], s10 offen offset:1280
    buffer_load_dwordx4 v[184:187], v2, s[52:55], s10 offen offset:2176
    buffer_load_dwordx4 v[188:191], v2, s[52:55], s10 offen offset:3072
    s_waitcnt lgkmcnt(0)
    ds_read_b64_tr_b16 v[48:49], v7 offset:8192
    ds_read_b64_tr_b16 v[50:51], v7 offset:8448
    ds_read_b64_tr_b16 v[52:53], v7 offset:8704
    ds_read_b64_tr_b16 v[54:55], v7 offset:8960
    ds_read_b64_tr_b16 v[56:57], v7 offset:9216
    ds_read_b64_tr_b16 v[58:59], v7 offset:9472
    ds_read_b64_tr_b16 v[60:61], v7 offset:9728
    ds_read_b64_tr_b16 v[62:63], v7 offset:9984
    s_mov_b64 vcc, s[72:73]
    s_waitcnt vmcnt(8)
    v_cndmask_b32_dpp v8, v148, v144, vcc quad_perm:[1,0,3,2] row_mask:0xf bank_mask:0xf
    v_cndmask_b32_dpp v9, v149, v145, vcc quad_perm:[1,0,3,2] row_mask:0xf bank_mask:0xf
    v_cndmask_b32_dpp v10, v150, v146, vcc quad_perm:[1,0,3,2] row_mask:0xf bank_mask:0xf
    v_cndmask_b32_dpp v11, v151, v147, vcc quad_perm:[1,0,3,2] row_mask:0xf bank_mask:0xf
    v_mfma_f32_32x32x16_bf16 v[96:111], v[20:23], v[136:139], v[96:111]
    v_cndmask_b32_dpp v132, v156, v152, vcc quad_perm:[1,0,3,2] row_mask:0xf bank_mask:0xf
    v_cndmask_b32_dpp v133, v157, v153, vcc quad_perm:[1,0,3,2] row_mask:0xf bank_mask:0xf
    v_cndmask_b32_dpp v134, v158, v154, vcc quad_perm:[1,0,3,2] row_mask:0xf bank_mask:0xf
    v_cndmask_b32_dpp v135, v159, v155, vcc quad_perm:[1,0,3,2] row_mask:0xf bank_mask:0xf
    s_not_b64 vcc, s[72:73]
    v_cndmask_b32_dpp v148, v144, v148, vcc quad_perm:[1,0,3,2] row_mask:0xf bank_mask:0xf
    v_cndmask_b32_dpp v149, v145, v149, vcc quad_perm:[1,0,3,2] row_mask:0xf bank_mask:0xf
    v_cndmask_b32_dpp v150, v146, v150, vcc quad_perm:[1,0,3,2] row_mask:0xf bank_mask:0xf
    v_cndmask_b32_dpp v151, v147, v151, vcc quad_perm:[1,0,3,2] row_mask:0xf bank_mask:0xf
    v_cndmask_b32_dpp v156, v152, v156, vcc quad_perm:[1,0,3,2] row_mask:0xf bank_mask:0xf
    v_mfma_f32_32x32x16_bf16 v[96:111], v[28:31], v[140:143], v[96:111]
    v_cndmask_b32_dpp v157, v153, v157, vcc quad_perm:[1,0,3,2] row_mask:0xf bank_mask:0xf
    v_cndmask_b32_dpp v158, v154, v158, vcc quad_perm:[1,0,3,2] row_mask:0xf bank_mask:0xf
    v_cndmask_b32_dpp v159, v155, v159, vcc quad_perm:[1,0,3,2] row_mask:0xf bank_mask:0xf
    s_mov_b64 vcc, s[76:77]
    v_cndmask_b32_dpp v144, v132, v8, vcc quad_perm:[2,3,0,1] row_mask:0xf bank_mask:0xf
    v_cndmask_b32_dpp v145, v133, v9, vcc quad_perm:[2,3,0,1] row_mask:0xf bank_mask:0xf
    v_cndmask_b32_dpp v146, v134, v10, vcc quad_perm:[2,3,0,1] row_mask:0xf bank_mask:0xf
    v_cndmask_b32_dpp v147, v135, v11, vcc quad_perm:[2,3,0,1] row_mask:0xf bank_mask:0xf
    v_cndmask_b32_dpp v152, v156, v148, vcc quad_perm:[2,3,0,1] row_mask:0xf bank_mask:0xf
    v_cndmask_b32_dpp v153, v157, v149, vcc quad_perm:[2,3,0,1] row_mask:0xf bank_mask:0xf
    v_mfma_f32_32x32x16_bf16 v[96:111], v[32:35], v[144:147], v[96:111]
    v_cndmask_b32_dpp v154, v158, v150, vcc quad_perm:[2,3,0,1] row_mask:0xf bank_mask:0xf
    v_cndmask_b32_dpp v155, v159, v151, vcc quad_perm:[2,3,0,1] row_mask:0xf bank_mask:0xf
    s_not_b64 vcc, s[76:77]
    v_cndmask_b32_dpp v132, v8, v132, vcc quad_perm:[2,3,0,1] row_mask:0xf bank_mask:0xf
    v_cndmask_b32_dpp v133, v9, v133, vcc quad_perm:[2,3,0,1] row_mask:0xf bank_mask:0xf
    v_cndmask_b32_dpp v134, v10, v134, vcc quad_perm:[2,3,0,1] row_mask:0xf bank_mask:0xf
    v_cndmask_b32_dpp v135, v11, v135, vcc quad_perm:[2,3,0,1] row_mask:0xf bank_mask:0xf
    v_cndmask_b32_dpp v156, v148, v156, vcc quad_perm:[2,3,0,1] row_mask:0xf bank_mask:0xf
    v_cndmask_b32_dpp v157, v149, v157, vcc quad_perm:[2,3,0,1] row_mask:0xf bank_mask:0xf
    v_cndmask_b32_dpp v158, v150, v158, vcc quad_perm:[2,3,0,1] row_mask:0xf bank_mask:0xf
    v_mfma_f32_32x32x16_bf16 v[96:111], v[40:43], v[132:135], v[96:111]
    v_cndmask_b32_dpp v159, v151, v159, vcc quad_perm:[2,3,0,1] row_mask:0xf bank_mask:0xf
    buffer_load_dwordx4 v[128:131], v2, s[52:55], s10 offen offset:512
    buffer_load_dwordx4 v[132:135], v2, s[52:55], s10 offen offset:1408
    buffer_load_dwordx4 v[136:139], v2, s[52:55], s10 offen offset:2304
    buffer_load_dwordx4 v[140:143], v2, s[52:55], s10 offen offset:3200
    s_waitcnt lgkmcnt(0)
    ds_read_b64_tr_b16 v[64:65], v7 offset:12288
    ds_read_b64_tr_b16 v[66:67], v7 offset:12544
    ds_read_b64_tr_b16 v[68:69], v7 offset:12800
    ds_read_b64_tr_b16 v[70:71], v7 offset:13056
    ds_read_b64_tr_b16 v[72:73], v7 offset:13312
    ds_read_b64_tr_b16 v[74:75], v7 offset:13568
    ds_read_b64_tr_b16 v[76:77], v7 offset:13824
    ds_read_b64_tr_b16 v[78:79], v7 offset:14080
    s_mov_b64 vcc, s[72:73]
    s_waitcnt vmcnt(8)
    v_cndmask_b32_dpp v8, v164, v160, vcc quad_perm:[1,0,3,2] row_mask:0xf bank_mask:0xf
    v_cndmask_b32_dpp v9, v165, v161, vcc quad_perm:[1,0,3,2] row_mask:0xf bank_mask:0xf
    v_cndmask_b32_dpp v10, v166, v162, vcc quad_perm:[1,0,3,2] row_mask:0xf bank_mask:0xf
    v_cndmask_b32_dpp v11, v167, v163, vcc quad_perm:[1,0,3,2] row_mask:0xf bank_mask:0xf
    v_mfma_f32_32x32x16_bf16 v[96:111], v[36:39], v[152:155], v[96:111]
    v_cndmask_b32_dpp v148, v172, v168, vcc quad_perm:[1,0,3,2] row_mask:0xf bank_mask:0xf
    v_cndmask_b32_dpp v149, v173, v169, vcc quad_perm:[1,0,3,2] row_mask:0xf bank_mask:0xf
    v_cndmask_b32_dpp v150, v174, v170, vcc quad_perm:[1,0,3,2] row_mask:0xf bank_mask:0xf
    v_cndmask_b32_dpp v151, v175, v171, vcc quad_perm:[1,0,3,2] row_mask:0xf bank_mask:0xf
    s_not_b64 vcc, s[72:73]
    v_cndmask_b32_dpp v164, v160, v164, vcc quad_perm:[1,0,3,2] row_mask:0xf bank_mask:0xf
    v_cndmask_b32_dpp v165, v161, v165, vcc quad_perm:[1,0,3,2] row_mask:0xf bank_mask:0xf
    v_cndmask_b32_dpp v166, v162, v166, vcc quad_perm:[1,0,3,2] row_mask:0xf bank_mask:0xf
    v_cndmask_b32_dpp v167, v163, v167, vcc quad_perm:[1,0,3,2] row_mask:0xf bank_mask:0xf
    v_cndmask_b32_dpp v172, v168, v172, vcc quad_perm:[1,0,3,2] row_mask:0xf bank_mask:0xf
    v_mfma_f32_32x32x16_bf16 v[96:111], v[44:47], v[156:159], v[96:111]
    v_cndmask_b32_dpp v173, v169, v173, vcc quad_perm:[1,0,3,2] row_mask:0xf bank_mask:0xf
    v_cndmask_b32_dpp v174, v170, v174, vcc quad_perm:[1,0,3,2] row_mask:0xf bank_mask:0xf
    v_cndmask_b32_dpp v175, v171, v175, vcc quad_perm:[1,0,3,2] row_mask:0xf bank_mask:0xf
    s_mov_b64 vcc, s[76:77]
    v_cndmask_b32_dpp v160, v148, v8, vcc quad_perm:[2,3,0,1] row_mask:0xf bank_mask:0xf
    v_cndmask_b32_dpp v161, v149, v9, vcc quad_perm:[2,3,0,1] row_mask:0xf bank_mask:0xf
    v_cndmask_b32_dpp v162, v150, v10, vcc quad_perm:[2,3,0,1] row_mask:0xf bank_mask:0xf
    v_cndmask_b32_dpp v163, v151, v11, vcc quad_perm:[2,3,0,1] row_mask:0xf bank_mask:0xf
    v_cndmask_b32_dpp v168, v172, v164, vcc quad_perm:[2,3,0,1] row_mask:0xf bank_mask:0xf
    v_cndmask_b32_dpp v169, v173, v165, vcc quad_perm:[2,3,0,1] row_mask:0xf bank_mask:0xf
    v_mfma_f32_32x32x16_bf16 v[96:111], v[48:51], v[160:163], v[96:111]
    v_cndmask_b32_dpp v170, v174, v166, vcc quad_perm:[2,3,0,1] row_mask:0xf bank_mask:0xf
    v_cndmask_b32_dpp v171, v175, v167, vcc quad_perm:[2,3,0,1] row_mask:0xf bank_mask:0xf
    s_not_b64 vcc, s[76:77]
    v_cndmask_b32_dpp v148, v8, v148, vcc quad_perm:[2,3,0,1] row_mask:0xf bank_mask:0xf
    v_cndmask_b32_dpp v149, v9, v149, vcc quad_perm:[2,3,0,1] row_mask:0xf bank_mask:0xf
    v_cndmask_b32_dpp v150, v10, v150, vcc quad_perm:[2,3,0,1] row_mask:0xf bank_mask:0xf
    v_cndmask_b32_dpp v151, v11, v151, vcc quad_perm:[2,3,0,1] row_mask:0xf bank_mask:0xf
    v_cndmask_b32_dpp v172, v164, v172, vcc quad_perm:[2,3,0,1] row_mask:0xf bank_mask:0xf
    v_cndmask_b32_dpp v173, v165, v173, vcc quad_perm:[2,3,0,1] row_mask:0xf bank_mask:0xf
    v_cndmask_b32_dpp v174, v166, v174, vcc quad_perm:[2,3,0,1] row_mask:0xf bank_mask:0xf
    v_mfma_f32_32x32x16_bf16 v[96:111], v[56:59], v[148:151], v[96:111]
    v_cndmask_b32_dpp v175, v167, v175, vcc quad_perm:[2,3,0,1] row_mask:0xf bank_mask:0xf
    buffer_load_dwordx4 v[144:147], v2, s[52:55], s10 offen offset:640
    buffer_load_dwordx4 v[148:151], v2, s[52:55], s10 offen offset:1536
    buffer_load_dwordx4 v[152:155], v2, s[52:55], s10 offen offset:2432
    buffer_load_dwordx4 v[156:159], v2, s[52:55], s10 offen offset:3328
    s_waitcnt lgkmcnt(0)
    ds_read_b64_tr_b16 v[16:17], v7 offset:16384
    ds_read_b64_tr_b16 v[18:19], v7 offset:16640
    ds_read_b64_tr_b16 v[20:21], v7 offset:16896
    ds_read_b64_tr_b16 v[22:23], v7 offset:17152
    ds_read_b64_tr_b16 v[24:25], v7 offset:17408
    ds_read_b64_tr_b16 v[26:27], v7 offset:17664
    ds_read_b64_tr_b16 v[28:29], v7 offset:17920
    ds_read_b64_tr_b16 v[30:31], v7 offset:18176
    s_mov_b64 vcc, s[72:73]
    s_waitcnt vmcnt(8)
    v_cndmask_b32_dpp v8, v180, v176, vcc quad_perm:[1,0,3,2] row_mask:0xf bank_mask:0xf
    v_cndmask_b32_dpp v9, v181, v177, vcc quad_perm:[1,0,3,2] row_mask:0xf bank_mask:0xf
    v_cndmask_b32_dpp v10, v182, v178, vcc quad_perm:[1,0,3,2] row_mask:0xf bank_mask:0xf
    v_cndmask_b32_dpp v11, v183, v179, vcc quad_perm:[1,0,3,2] row_mask:0xf bank_mask:0xf
    v_mfma_f32_32x32x16_bf16 v[96:111], v[52:55], v[168:171], v[96:111]
    v_cndmask_b32_dpp v164, v188, v184, vcc quad_perm:[1,0,3,2] row_mask:0xf bank_mask:0xf
    v_cndmask_b32_dpp v165, v189, v185, vcc quad_perm:[1,0,3,2] row_mask:0xf bank_mask:0xf
    v_cndmask_b32_dpp v166, v190, v186, vcc quad_perm:[1,0,3,2] row_mask:0xf bank_mask:0xf
    v_cndmask_b32_dpp v167, v191, v187, vcc quad_perm:[1,0,3,2] row_mask:0xf bank_mask:0xf
    s_not_b64 vcc, s[72:73]
    v_cndmask_b32_dpp v180, v176, v180, vcc quad_perm:[1,0,3,2] row_mask:0xf bank_mask:0xf
    v_cndmask_b32_dpp v181, v177, v181, vcc quad_perm:[1,0,3,2] row_mask:0xf bank_mask:0xf
    v_cndmask_b32_dpp v182, v178, v182, vcc quad_perm:[1,0,3,2] row_mask:0xf bank_mask:0xf
    v_cndmask_b32_dpp v183, v179, v183, vcc quad_perm:[1,0,3,2] row_mask:0xf bank_mask:0xf
    v_cndmask_b32_dpp v188, v184, v188, vcc quad_perm:[1,0,3,2] row_mask:0xf bank_mask:0xf
    v_mfma_f32_32x32x16_bf16 v[96:111], v[60:63], v[172:175], v[96:111]
    v_cndmask_b32_dpp v189, v185, v189, vcc quad_perm:[1,0,3,2] row_mask:0xf bank_mask:0xf
    v_cndmask_b32_dpp v190, v186, v190, vcc quad_perm:[1,0,3,2] row_mask:0xf bank_mask:0xf
    v_cndmask_b32_dpp v191, v187, v191, vcc quad_perm:[1,0,3,2] row_mask:0xf bank_mask:0xf
    s_mov_b64 vcc, s[76:77]
    v_cndmask_b32_dpp v176, v164, v8, vcc quad_perm:[2,3,0,1] row_mask:0xf bank_mask:0xf
    v_cndmask_b32_dpp v177, v165, v9, vcc quad_perm:[2,3,0,1] row_mask:0xf bank_mask:0xf
    v_cndmask_b32_dpp v178, v166, v10, vcc quad_perm:[2,3,0,1] row_mask:0xf bank_mask:0xf
    v_cndmask_b32_dpp v179, v167, v11, vcc quad_perm:[2,3,0,1] row_mask:0xf bank_mask:0xf
    v_cndmask_b32_dpp v184, v188, v180, vcc quad_perm:[2,3,0,1] row_mask:0xf bank_mask:0xf
    v_cndmask_b32_dpp v185, v189, v181, vcc quad_perm:[2,3,0,1] row_mask:0xf bank_mask:0xf
    v_mfma_f32_32x32x16_bf16 v[96:111], v[64:67], v[176:179], v[96:111]
    v_cndmask_b32_dpp v186, v190, v182, vcc quad_perm:[2,3,0,1] row_mask:0xf bank_mask:0xf
    v_cndmask_b32_dpp v187, v191, v183, vcc quad_perm:[2,3,0,1] row_mask:0xf bank_mask:0xf
    s_not_b64 vcc, s[76:77]
    v_cndmask_b32_dpp v164, v8, v164, vcc quad_perm:[2,3,0,1] row_mask:0xf bank_mask:0xf
    v_cndmask_b32_dpp v165, v9, v165, vcc quad_perm:[2,3,0,1] row_mask:0xf bank_mask:0xf
    v_cndmask_b32_dpp v166, v10, v166, vcc quad_perm:[2,3,0,1] row_mask:0xf bank_mask:0xf
    v_cndmask_b32_dpp v167, v11, v167, vcc quad_perm:[2,3,0,1] row_mask:0xf bank_mask:0xf
    v_cndmask_b32_dpp v188, v180, v188, vcc quad_perm:[2,3,0,1] row_mask:0xf bank_mask:0xf
    v_cndmask_b32_dpp v189, v181, v189, vcc quad_perm:[2,3,0,1] row_mask:0xf bank_mask:0xf
    v_cndmask_b32_dpp v190, v182, v190, vcc quad_perm:[2,3,0,1] row_mask:0xf bank_mask:0xf
    v_mfma_f32_32x32x16_bf16 v[96:111], v[72:75], v[164:167], v[96:111]
    v_cndmask_b32_dpp v191, v183, v191, vcc quad_perm:[2,3,0,1] row_mask:0xf bank_mask:0xf
    buffer_load_dwordx4 v[160:163], v2, s[52:55], s10 offen offset:768
    buffer_load_dwordx4 v[164:167], v2, s[52:55], s10 offen offset:1664
    buffer_load_dwordx4 v[168:171], v2, s[52:55], s10 offen offset:2560
    buffer_load_dwordx4 v[172:175], v2, s[52:55], s10 offen offset:3456
    s_waitcnt lgkmcnt(0)
    ds_read_b64_tr_b16 v[32:33], v7 offset:20480
    ds_read_b64_tr_b16 v[34:35], v7 offset:20736
    ds_read_b64_tr_b16 v[36:37], v7 offset:20992
    ds_read_b64_tr_b16 v[38:39], v7 offset:21248
    ds_read_b64_tr_b16 v[40:41], v7 offset:21504
    ds_read_b64_tr_b16 v[42:43], v7 offset:21760
    ds_read_b64_tr_b16 v[44:45], v7 offset:22016
    ds_read_b64_tr_b16 v[46:47], v7 offset:22272
    s_mov_b64 vcc, s[72:73]
    s_waitcnt vmcnt(8)
    v_cndmask_b32_dpp v8, v132, v128, vcc quad_perm:[1,0,3,2] row_mask:0xf bank_mask:0xf
    v_cndmask_b32_dpp v9, v133, v129, vcc quad_perm:[1,0,3,2] row_mask:0xf bank_mask:0xf
    v_cndmask_b32_dpp v10, v134, v130, vcc quad_perm:[1,0,3,2] row_mask:0xf bank_mask:0xf
    v_cndmask_b32_dpp v11, v135, v131, vcc quad_perm:[1,0,3,2] row_mask:0xf bank_mask:0xf
    v_mfma_f32_32x32x16_bf16 v[96:111], v[68:71], v[184:187], v[96:111]
    v_cndmask_b32_dpp v180, v140, v136, vcc quad_perm:[1,0,3,2] row_mask:0xf bank_mask:0xf
    v_cndmask_b32_dpp v181, v141, v137, vcc quad_perm:[1,0,3,2] row_mask:0xf bank_mask:0xf
    v_cndmask_b32_dpp v182, v142, v138, vcc quad_perm:[1,0,3,2] row_mask:0xf bank_mask:0xf
    v_cndmask_b32_dpp v183, v143, v139, vcc quad_perm:[1,0,3,2] row_mask:0xf bank_mask:0xf
    s_not_b64 vcc, s[72:73]
    v_cndmask_b32_dpp v132, v128, v132, vcc quad_perm:[1,0,3,2] row_mask:0xf bank_mask:0xf
    v_cndmask_b32_dpp v133, v129, v133, vcc quad_perm:[1,0,3,2] row_mask:0xf bank_mask:0xf
    v_cndmask_b32_dpp v134, v130, v134, vcc quad_perm:[1,0,3,2] row_mask:0xf bank_mask:0xf
    v_cndmask_b32_dpp v135, v131, v135, vcc quad_perm:[1,0,3,2] row_mask:0xf bank_mask:0xf
    v_cndmask_b32_dpp v140, v136, v140, vcc quad_perm:[1,0,3,2] row_mask:0xf bank_mask:0xf
    v_mfma_f32_32x32x16_bf16 v[96:111], v[76:79], v[188:191], v[96:111]
    v_cndmask_b32_dpp v141, v137, v141, vcc quad_perm:[1,0,3,2] row_mask:0xf bank_mask:0xf
    v_cndmask_b32_dpp v142, v138, v142, vcc quad_perm:[1,0,3,2] row_mask:0xf bank_mask:0xf
    v_cndmask_b32_dpp v143, v139, v143, vcc quad_perm:[1,0,3,2] row_mask:0xf bank_mask:0xf
    s_mov_b64 vcc, s[76:77]
    v_cndmask_b32_dpp v128, v180, v8, vcc quad_perm:[2,3,0,1] row_mask:0xf bank_mask:0xf
    v_cndmask_b32_dpp v129, v181, v9, vcc quad_perm:[2,3,0,1] row_mask:0xf bank_mask:0xf
    v_cndmask_b32_dpp v130, v182, v10, vcc quad_perm:[2,3,0,1] row_mask:0xf bank_mask:0xf
    v_cndmask_b32_dpp v131, v183, v11, vcc quad_perm:[2,3,0,1] row_mask:0xf bank_mask:0xf
    v_cndmask_b32_dpp v136, v140, v132, vcc quad_perm:[2,3,0,1] row_mask:0xf bank_mask:0xf
    v_cndmask_b32_dpp v137, v141, v133, vcc quad_perm:[2,3,0,1] row_mask:0xf bank_mask:0xf
    v_mfma_f32_32x32x16_bf16 v[96:111], v[16:19], v[128:131], v[96:111]
    v_cndmask_b32_dpp v138, v142, v134, vcc quad_perm:[2,3,0,1] row_mask:0xf bank_mask:0xf
    v_cndmask_b32_dpp v139, v143, v135, vcc quad_perm:[2,3,0,1] row_mask:0xf bank_mask:0xf
    s_not_b64 vcc, s[76:77]
    v_cndmask_b32_dpp v180, v8, v180, vcc quad_perm:[2,3,0,1] row_mask:0xf bank_mask:0xf
    v_cndmask_b32_dpp v181, v9, v181, vcc quad_perm:[2,3,0,1] row_mask:0xf bank_mask:0xf
    v_cndmask_b32_dpp v182, v10, v182, vcc quad_perm:[2,3,0,1] row_mask:0xf bank_mask:0xf
    v_cndmask_b32_dpp v183, v11, v183, vcc quad_perm:[2,3,0,1] row_mask:0xf bank_mask:0xf
    v_cndmask_b32_dpp v140, v132, v140, vcc quad_perm:[2,3,0,1] row_mask:0xf bank_mask:0xf
    v_cndmask_b32_dpp v141, v133, v141, vcc quad_perm:[2,3,0,1] row_mask:0xf bank_mask:0xf
    v_cndmask_b32_dpp v142, v134, v142, vcc quad_perm:[2,3,0,1] row_mask:0xf bank_mask:0xf
    v_mfma_f32_32x32x16_bf16 v[96:111], v[24:27], v[180:183], v[96:111]
    v_cndmask_b32_dpp v143, v135, v143, vcc quad_perm:[2,3,0,1] row_mask:0xf bank_mask:0xf
    s_waitcnt lgkmcnt(0)
    ds_read_b64_tr_b16 v[48:49], v7 offset:24576
    ds_read_b64_tr_b16 v[50:51], v7 offset:24832
    ds_read_b64_tr_b16 v[52:53], v7 offset:25088
    ds_read_b64_tr_b16 v[54:55], v7 offset:25344
    ds_read_b64_tr_b16 v[56:57], v7 offset:25600
    ds_read_b64_tr_b16 v[58:59], v7 offset:25856
    ds_read_b64_tr_b16 v[60:61], v7 offset:26112
    ds_read_b64_tr_b16 v[62:63], v7 offset:26368
    s_mov_b64 vcc, s[72:73]
    s_waitcnt vmcnt(4)
    v_cndmask_b32_dpp v8, v148, v144, vcc quad_perm:[1,0,3,2] row_mask:0xf bank_mask:0xf
    v_cndmask_b32_dpp v9, v149, v145, vcc quad_perm:[1,0,3,2] row_mask:0xf bank_mask:0xf
    v_cndmask_b32_dpp v10, v150, v146, vcc quad_perm:[1,0,3,2] row_mask:0xf bank_mask:0xf
    v_cndmask_b32_dpp v11, v151, v147, vcc quad_perm:[1,0,3,2] row_mask:0xf bank_mask:0xf
    v_mfma_f32_32x32x16_bf16 v[96:111], v[20:23], v[136:139], v[96:111]
    v_cndmask_b32_dpp v132, v156, v152, vcc quad_perm:[1,0,3,2] row_mask:0xf bank_mask:0xf
    v_cndmask_b32_dpp v133, v157, v153, vcc quad_perm:[1,0,3,2] row_mask:0xf bank_mask:0xf
    v_cndmask_b32_dpp v134, v158, v154, vcc quad_perm:[1,0,3,2] row_mask:0xf bank_mask:0xf
    v_cndmask_b32_dpp v135, v159, v155, vcc quad_perm:[1,0,3,2] row_mask:0xf bank_mask:0xf
    s_not_b64 vcc, s[72:73]
    v_cndmask_b32_dpp v148, v144, v148, vcc quad_perm:[1,0,3,2] row_mask:0xf bank_mask:0xf
    v_cndmask_b32_dpp v149, v145, v149, vcc quad_perm:[1,0,3,2] row_mask:0xf bank_mask:0xf
    v_cndmask_b32_dpp v150, v146, v150, vcc quad_perm:[1,0,3,2] row_mask:0xf bank_mask:0xf
    v_cndmask_b32_dpp v151, v147, v151, vcc quad_perm:[1,0,3,2] row_mask:0xf bank_mask:0xf
    v_cndmask_b32_dpp v156, v152, v156, vcc quad_perm:[1,0,3,2] row_mask:0xf bank_mask:0xf
    v_mfma_f32_32x32x16_bf16 v[96:111], v[28:31], v[140:143], v[96:111]
    v_cndmask_b32_dpp v157, v153, v157, vcc quad_perm:[1,0,3,2] row_mask:0xf bank_mask:0xf
    v_cndmask_b32_dpp v158, v154, v158, vcc quad_perm:[1,0,3,2] row_mask:0xf bank_mask:0xf
    v_cndmask_b32_dpp v159, v155, v159, vcc quad_perm:[1,0,3,2] row_mask:0xf bank_mask:0xf
    s_mov_b64 vcc, s[76:77]
    v_cndmask_b32_dpp v144, v132, v8, vcc quad_perm:[2,3,0,1] row_mask:0xf bank_mask:0xf
    v_cndmask_b32_dpp v145, v133, v9, vcc quad_perm:[2,3,0,1] row_mask:0xf bank_mask:0xf
    v_cndmask_b32_dpp v146, v134, v10, vcc quad_perm:[2,3,0,1] row_mask:0xf bank_mask:0xf
    v_cndmask_b32_dpp v147, v135, v11, vcc quad_perm:[2,3,0,1] row_mask:0xf bank_mask:0xf
    v_cndmask_b32_dpp v152, v156, v148, vcc quad_perm:[2,3,0,1] row_mask:0xf bank_mask:0xf
    v_cndmask_b32_dpp v153, v157, v149, vcc quad_perm:[2,3,0,1] row_mask:0xf bank_mask:0xf
    v_mfma_f32_32x32x16_bf16 v[96:111], v[32:35], v[144:147], v[96:111]
    v_cndmask_b32_dpp v154, v158, v150, vcc quad_perm:[2,3,0,1] row_mask:0xf bank_mask:0xf
    v_cndmask_b32_dpp v155, v159, v151, vcc quad_perm:[2,3,0,1] row_mask:0xf bank_mask:0xf
    s_not_b64 vcc, s[76:77]
    v_cndmask_b32_dpp v132, v8, v132, vcc quad_perm:[2,3,0,1] row_mask:0xf bank_mask:0xf
    v_cndmask_b32_dpp v133, v9, v133, vcc quad_perm:[2,3,0,1] row_mask:0xf bank_mask:0xf
    v_cndmask_b32_dpp v134, v10, v134, vcc quad_perm:[2,3,0,1] row_mask:0xf bank_mask:0xf
    v_cndmask_b32_dpp v135, v11, v135, vcc quad_perm:[2,3,0,1] row_mask:0xf bank_mask:0xf
    v_cndmask_b32_dpp v156, v148, v156, vcc quad_perm:[2,3,0,1] row_mask:0xf bank_mask:0xf
    v_cndmask_b32_dpp v157, v149, v157, vcc quad_perm:[2,3,0,1] row_mask:0xf bank_mask:0xf
    v_cndmask_b32_dpp v158, v150, v158, vcc quad_perm:[2,3,0,1] row_mask:0xf bank_mask:0xf
    v_mfma_f32_32x32x16_bf16 v[96:111], v[40:43], v[132:135], v[96:111]
    v_cndmask_b32_dpp v159, v151, v159, vcc quad_perm:[2,3,0,1] row_mask:0xf bank_mask:0xf
    s_waitcnt lgkmcnt(0)
    s_mov_b64 vcc, s[72:73]
    s_waitcnt vmcnt(0)
    v_lshlrev_b32 v2, 4, v1
    v_cndmask_b32_dpp v8, v164, v160, vcc quad_perm:[1,0,3,2] row_mask:0xf bank_mask:0xf
    v_cndmask_b32_dpp v9, v165, v161, vcc quad_perm:[1,0,3,2] row_mask:0xf bank_mask:0xf
    v_cndmask_b32_dpp v10, v166, v162, vcc quad_perm:[1,0,3,2] row_mask:0xf bank_mask:0xf
    v_cndmask_b32_dpp v11, v167, v163, vcc quad_perm:[1,0,3,2] row_mask:0xf bank_mask:0xf
    v_mfma_f32_32x32x16_bf16 v[96:111], v[36:39], v[152:155], v[96:111]
    v_cndmask_b32_dpp v148, v172, v168, vcc quad_perm:[1,0,3,2] row_mask:0xf bank_mask:0xf
    v_cndmask_b32_dpp v149, v173, v169, vcc quad_perm:[1,0,3,2] row_mask:0xf bank_mask:0xf
    v_cndmask_b32_dpp v150, v174, v170, vcc quad_perm:[1,0,3,2] row_mask:0xf bank_mask:0xf
    v_cndmask_b32_dpp v151, v175, v171, vcc quad_perm:[1,0,3,2] row_mask:0xf bank_mask:0xf
    s_not_b64 vcc, s[72:73]
    v_cndmask_b32_dpp v164, v160, v164, vcc quad_perm:[1,0,3,2] row_mask:0xf bank_mask:0xf
    v_cndmask_b32_dpp v165, v161, v165, vcc quad_perm:[1,0,3,2] row_mask:0xf bank_mask:0xf
    v_cndmask_b32_dpp v166, v162, v166, vcc quad_perm:[1,0,3,2] row_mask:0xf bank_mask:0xf
    v_cndmask_b32_dpp v167, v163, v167, vcc quad_perm:[1,0,3,2] row_mask:0xf bank_mask:0xf
    v_cndmask_b32_dpp v172, v168, v172, vcc quad_perm:[1,0,3,2] row_mask:0xf bank_mask:0xf
    v_mfma_f32_32x32x16_bf16 v[96:111], v[44:47], v[156:159], v[96:111]
    v_cndmask_b32_dpp v173, v169, v173, vcc quad_perm:[1,0,3,2] row_mask:0xf bank_mask:0xf
    v_cndmask_b32_dpp v174, v170, v174, vcc quad_perm:[1,0,3,2] row_mask:0xf bank_mask:0xf
    v_cndmask_b32_dpp v175, v171, v175, vcc quad_perm:[1,0,3,2] row_mask:0xf bank_mask:0xf
    s_mov_b64 vcc, s[76:77]
    v_cndmask_b32_dpp v160, v148, v8, vcc quad_perm:[2,3,0,1] row_mask:0xf bank_mask:0xf
    v_cndmask_b32_dpp v161, v149, v9, vcc quad_perm:[2,3,0,1] row_mask:0xf bank_mask:0xf
    v_cndmask_b32_dpp v162, v150, v10, vcc quad_perm:[2,3,0,1] row_mask:0xf bank_mask:0xf
    v_cndmask_b32_dpp v163, v151, v11, vcc quad_perm:[2,3,0,1] row_mask:0xf bank_mask:0xf
    v_cndmask_b32_dpp v168, v172, v164, vcc quad_perm:[2,3,0,1] row_mask:0xf bank_mask:0xf
    v_cndmask_b32_dpp v169, v173, v165, vcc quad_perm:[2,3,0,1] row_mask:0xf bank_mask:0xf
    v_mfma_f32_32x32x16_bf16 v[96:111], v[48:51], v[160:163], v[96:111]
    v_cndmask_b32_dpp v170, v174, v166, vcc quad_perm:[2,3,0,1] row_mask:0xf bank_mask:0xf
    v_cndmask_b32_dpp v171, v175, v167, vcc quad_perm:[2,3,0,1] row_mask:0xf bank_mask:0xf
    s_not_b64 vcc, s[76:77]
    v_cndmask_b32_dpp v148, v8, v148, vcc quad_perm:[2,3,0,1] row_mask:0xf bank_mask:0xf
    v_cndmask_b32_dpp v149, v9, v149, vcc quad_perm:[2,3,0,1] row_mask:0xf bank_mask:0xf
    v_cndmask_b32_dpp v150, v10, v150, vcc quad_perm:[2,3,0,1] row_mask:0xf bank_mask:0xf
    v_cndmask_b32_dpp v151, v11, v151, vcc quad_perm:[2,3,0,1] row_mask:0xf bank_mask:0xf
    v_cndmask_b32_dpp v172, v164, v172, vcc quad_perm:[2,3,0,1] row_mask:0xf bank_mask:0xf
    v_cndmask_b32_dpp v173, v165, v173, vcc quad_perm:[2,3,0,1] row_mask:0xf bank_mask:0xf
    v_cndmask_b32_dpp v174, v166, v174, vcc quad_perm:[2,3,0,1] row_mask:0xf bank_mask:0xf
    v_mfma_f32_32x32x16_bf16 v[96:111], v[56:59], v[148:151], v[96:111]
    v_cndmask_b32_dpp v175, v167, v175, vcc quad_perm:[2,3,0,1] row_mask:0xf bank_mask:0xf
    v_mfma_f32_32x32x16_bf16 v[96:111], v[52:55], v[168:171], v[96:111]
    s_nop 0
    v_mfma_f32_32x32x16_bf16 v[96:111], v[60:63], v[172:175], v[96:111]
    s_mov_b32 s12, 0x3e8b97f6
    s_mov_b32 s14, 0
    s_mov_b32 s15, -1
    s_lshl_b32 s5, s3, 11
    s_add_u32 s5, s5, 73728
    v_add_u32 v12, s5, v2
    s_add_u32 s5, s3, 1
    s_and_b32 s5, s5, 3
    s_lshl_b32 s6, s5, 11
    s_add_u32 s6, s6, 73728
    v_add_u32 v5, s6, v2
    s_mul_i32 s6, s5, 12288
    s_add_u32 s6, s6, 0
    v_add_u32 v8, s6, v2
    s_add_u32 s5, s3, 2
    s_and_b32 s5, s5, 3
    s_lshl_b32 s6, s5, 11
    s_add_u32 s6, s6, 73728
    v_add_u32 v6, s6, v2
    s_mul_i32 s6, s5, 12288
    s_add_u32 s6, s6, 4096
    v_add_u32 v9, s6, v2
    s_add_u32 s5, s3, 3
    s_and_b32 s5, s5, 3
    s_lshl_b32 s6, s5, 11
    s_add_u32 s6, s6, 73728
    v_add_u32 v7, s6, v2
    s_mul_i32 s6, s5, 12288
    s_add_u32 s6, s6, 8192
    v_add_u32 v10, s6, v2
    s_mul_i32 s6, s3, 12288
    v_add_u32 v11, s6, v2
    v_mul_f32 v15, 0xbfb8aa3b, v108
    v_pk_mul_f32 v[96:97], v[96:97], s[12:13] op_sel_hi:[1,0]
    v_pk_mul_f32 v[98:99], v[98:99], s[12:13] op_sel_hi:[1,0]
    v_pk_mul_f32 v[100:101], v[100:101], s[12:13] op_sel_hi:[1,0]
    v_pk_mul_f32 v[102:103], v[102:103], s[12:13] op_sel_hi:[1,0]
    v_pk_mul_f32 v[104:105], v[104:105], s[12:13] op_sel_hi:[1,0]
    v_pk_mul_f32 v[106:107], v[106:107], s[12:13] op_sel_hi:[1,0]
    v_pk_mul_f32 v[108:109], v[108:109], s[12:13] op_sel_hi:[1,0]
    v_pk_mul_f32 v[110:111], v[110:111], s[12:13] op_sel_hi:[1,0]
    v_exp_f32 v15, v15
    v_cvt_pk_bf16_f32 v88, v96, v97
    v_cvt_pk_bf16_f32 v89, v98, v99
    v_cvt_pk_bf16_f32 v90, v100, v101
    v_cvt_pk_bf16_f32 v91, v102, v103
    v_cvt_pk_bf16_f32 v92, v104, v105
    v_cvt_pk_bf16_f32 v93, v106, v107
    v_cvt_pk_bf16_f32 v94, v108, v109
    v_cvt_pk_bf16_f32 v95, v110, v111
    v_cndmask_b32 v94, v94, 0, s[14:15]
    v_cndmask_b32 v95, v95, 0, s[14:15]
    ds_write_b128 v12, v[88:91]
    ds_write_b128 v12, v[92:95] offset:1024
    v_pk_mov_b32 v[24:25], 0, 0
    v_pk_mov_b32 v[26:27], 0, 0
    v_pk_mov_b32 v[28:29], 0, 0
    v_pk_mov_b32 v[30:31], 0, 0
    v_pk_mov_b32 v[248:249], 0, 0
    v_pk_mov_b32 v[250:251], 0, 0
    v_pk_mov_b32 v[252:253], 0, 0
    v_pk_mov_b32 v[254:255], 0, 0
    v_add_f32 v15, 1.0, v15
    v_rcp_f32 v15, v15
    s_waitcnt lgkmcnt(0)
    s_barrier
    ds_read_b128 v[64:67], v5
    ds_read_b128 v[68:71], v5 offset:1024
    ds_read_b128 v[72:75], v6
    ds_read_b128 v[76:79], v6 offset:1024
    ds_read_b128 v[80:83], v7
    ds_read_b128 v[84:87], v7 offset:1024
    v_mfma_f32_32x32x16_bf16 v[96:111], v[24:27], v[24:27], 0
    v_mfma_f32_32x32x16_bf16 v[112:127], v[24:27], v[24:27], 0
    v_mfma_f32_32x32x16_bf16 v[128:143], v[24:27], v[24:27], 0
    v_mfma_f32_32x32x16_bf16 v[144:159], v[24:27], v[24:27], 0
    v_not_b32 v4, s4
    s_mov_b32 s5, 0
    s_setprio 1
L_a_ag:
    s_and_b32 s6, s5, 7
    s_cmp_eq_u32 s6, 7
    s_cselect_b64 exec, 3, 1
    buffer_load_dword v4, v3, s[56:59], 0 offen sc1
    s_mov_b64 exec, -1
    s_add_u32 s5, s5, 1
    s_waitcnt vmcnt(0)
    v_cmp_eq_u32 vcc, s4, v4
    s_nop 1
    s_cmp_lg_u64 vcc, 0
    s_cbranch_scc1 L_a_agok
    s_sleep 1
    s_cmp_lt_u32 s5, 400000
    s_cbranch_scc1 L_a_ag
L_a_agok:
    buffer_load_dwordx4 v[192:195], v2, s[68:71], 0 offen offset:0 sc1
    buffer_load_dwordx4 v[196:199], v2, s[68:71], 0 offen offset:1024 sc1
    buffer_load_dwordx4 v[200:203], v2, s[68:71], 0 offen offset:2048 sc1
    buffer_load_dwordx4 v[204:207], v2, s[68:71], 0 offen offset:3072 sc1
    s_mov_b32 s13, 4096
    buffer_load_dwordx4 v[208:211], v2, s[68:71], s13 offen offset:0 sc1
    buffer_load_dwordx4 v[212:215], v2, s[68:71], s13 offen offset:1024 sc1
    buffer_load_dwordx4 v[216:219], v2, s[68:71], s13 offen offset:2048 sc1
    buffer_load_dwordx4 v[220:223], v2, s[68:71], s13 offen offset:3072 sc1
    s_mov_b32 s13, 8192
    buffer_load_dwordx4 v[224:227], v2, s[68:71], s13 offen offset:0 sc1
    buffer_load_dwordx4 v[228:231], v2, s[68:71], s13 offen offset:1024 sc1
    buffer_load_dwordx4 v[232:235], v2, s[68:71], s13 offen offset:2048 sc1
    buffer_load_dwordx4 v[236:239], v2, s[68:71], s13 offen offset:3072 sc1
    s_mov_b32 s13, 12288
    buffer_load_dwordx4 v[240:243], v2, s[68:71], s13 offen offset:0 sc1
    buffer_load_dwordx4 v[244:247], v2, s[68:71], s13 offen offset:1024 sc1
L_a_go:
    s_cmp_lg_u32 s3, 0
    s_cbranch_scc1 L_a_noalive
    s_lshl_b32 s5, s2, 7
    s_add_u32 s5, s5, 0x5000c
    v_mov_b32 v13, s4
    s_mov_b32 exec_lo, 1
    s_mov_b32 exec_hi, 0
    buffer_store_dword v13, off, s[56:59], s5 sc1
    s_mov_b64 exec, -1
L_a_noalive:
    s_cmp_lg_u32 s8, 0
    s_cbranch_scc1 L_a_nog
    s_lshl_b32 s5, s9, 8
    s_add_u32 s5, s5, 0x5ff00
    v_lshlrev_b32 v14, 3, v1
    v_sub_f32 v12, 1.0, v15
    v_mov_b32 v13, s4
    s_mov_b32 exec_lo, 0
    buffer_store_dwordx2 v[12:13], v14, s[56:59], s5 offen sc1
    s_mov_b32 exec_lo, -1
L_a_nog:
    s_setprio 1
    s_waitcnt vmcnt(12) lgkmcnt(0)
    v_mfma_f32_32x32x16_bf16 v[160:175], v[192:195], v[64:67], 0
    v_mfma_f32_32x32x16_bf16 v[160:175], v[196:199], v[68:71], v[160:175]
    s_mov_b32 s11, 0
    s_nop 9
    v_mfma_f32_32x32x16_bf16 v[176:191], v[192:195], v[72:75], 0
    .p2align 6
    s_nop 0
L_attn:
    v_exp_f32 v160, v160
    v_exp_f32 v161, v161
    v_exp_f32 v162, v162
    v_exp_f32 v163, v163
    v_mfma_f32_32x32x16_bf16 v[144:159], v[248:251], v[24:27], v[144:159]
    v_exp_f32 v164, v164
    v_exp_f32 v165, v165
    v_exp_f32 v166, v166
    v_exp_f32 v167, v167
    v_cvt_pk_bf16_f32 v16, v160, v161
    v_cvt_pk_bf16_f32 v17, v162, v163
    v_mfma_f32_32x32x16_bf16 v[176:191], v[196:199], v[76:79], v[176:191]
    v_exp_f32 v168, v168
    v_exp_f32 v169, v169
    v_exp_f32 v170, v170
    v_exp_f32 v171, v171
    v_cvt_pk_bf16_f32 v18, v164, v165
    v_cvt_pk_bf16_f32 v19, v166, v167
    v_mfma_f32_32x32x16_bf16 v[144:159], v[252:255], v[28:31], v[144:159]
    v_exp_f32 v172, v172
    v_exp_f32 v173, v173
    v_exp_f32 v174, v174
    v_exp_f32 v175, v175
    v_cvt_pk_bf16_f32 v20, v168, v169
    v_cvt_pk_bf16_f32 v21, v170, v171
    v_cvt_pk_bf16_f32 v22, v172, v173
    v_cvt_pk_bf16_f32 v23, v174, v175
    v_mfma_f32_32x32x16_bf16 v[160:175], v[192:195], v[80:83], 0
    s_waitcnt vmcnt(10)
    v_exp_f32 v176, v176
    v_exp_f32 v177, v177
    v_exp_f32 v178, v178
    v_exp_f32 v179, v179
    v_mfma_f32_32x32x16_bf16 v[96:111], v[200:203], v[16:19], v[96:111]
    buffer_load_dwordx4 v[248:251], v2, s[68:71], s13 offen offset:2048 sc1
    v_exp_f32 v180, v180
    v_exp_f32 v181, v181
    v_exp_f32 v182, v182
    v_exp_f32 v183, v183
    v_cvt_pk_bf16_f32 v24, v176, v177
    v_cvt_pk_bf16_f32 v25, v178, v179
    v_mfma_f32_32x32x16_bf16 v[160:175], v[196:199], v[84:87], v[160:175]
    buffer_load_dwordx4 v[252:255], v2, s[68:71], s13 offen offset:3072 sc1
    v_exp_f32 v184, v184
    v_exp_f32 v185, v185
    v_exp_f32 v186, v186
    v_exp_f32 v187, v187
    v_cvt_pk_bf16_f32 v26, v180, v181
    v_cvt_pk_bf16_f32 v27, v182, v183
    v_mfma_f32_32x32x16_bf16 v[96:111], v[204:207], v[20:23], v[96:111]
    s_add_u32 s13, s13, 4096
    v_exp_f32 v188, v188
    v_exp_f32 v189, v189
    v_exp_f32 v190, v190
    v_exp_f32 v191, v191
    v_cvt_pk_bf16_f32 v28, v184, v185
    v_cvt_pk_bf16_f32 v29, v186, v187
    v_cvt_pk_bf16_f32 v30, v188, v189
    v_cvt_pk_bf16_f32 v31, v190, v191
    v_mfma_f32_32x32x16_bf16 v[176:191], v[192:195], v[88:91], 0
    v_exp_f32 v160, v160
    v_exp_f32 v161, v161
    v_exp_f32 v162, v162
    v_exp_f32 v163, v163
    v_mfma_f32_32x32x16_bf16 v[112:127], v[200:203], v[24:27], v[112:127]
    v_exp_f32 v164, v164
    v_exp_f32 v165, v165
    v_exp_f32 v166, v166
    v_exp_f32 v167, v167
    v_cvt_pk_bf16_f32 v16, v160, v161
    v_cvt_pk_bf16_f32 v17, v162, v163
    v_mfma_f32_32x32x16_bf16 v[176:191], v[196:199], v[92:95], v[176:191]
    v_exp_f32 v168, v168
    v_exp_f32 v169, v169
    v_exp_f32 v170, v170
    v_exp_f32 v171, v171
    v_cvt_pk_bf16_f32 v18, v164, v165
    v_cvt_pk_bf16_f32 v19, v166, v167
    v_mfma_f32_32x32x16_bf16 v[112:127], v[204:207], v[28:31], v[112:127]
    s_waitcnt vmcnt(10)
    v_exp_f32 v172, v172
    v_exp_f32 v173, v173
    v_exp_f32 v174, v174
    v_exp_f32 v175, v175
    v_cvt_pk_bf16_f32 v20, v168, v169
    v_cvt_pk_bf16_f32 v21, v170, v171
    v_cvt_pk_bf16_f32 v22, v172, v173
    v_cvt_pk_bf16_f32 v23, v174, v175
    v_mfma_f32_32x32x16_bf16 v[160:175], v[208:211], v[64:67], 0
    buffer_load_dwordx4 v[192:195], v2, s[68:71], s13 offen offset:0 sc1
    v_exp_f32 v176, v176
    v_exp_f32 v177, v177
    v_exp_f32 v178, v178
    v_exp_f32 v179, v179
    v_mfma_f32_32x32x16_bf16 v[128:143], v[200:203], v[16:19], v[128:143]
    buffer_load_dwordx4 v[196:199], v2, s[68:71], s13 offen offset:1024 sc1
    v_exp_f32 v180, v180
    v_exp_f32 v181, v181
    v_exp_f32 v182, v182
    v_exp_f32 v183, v183
    v_cvt_pk_bf16_f32 v24, v176, v177
    v_cvt_pk_bf16_f32 v25, v178, v179
    v_mfma_f32_32x32x16_bf16 v[160:175], v[212:215], v[68:71], v[160:175]
    v_exp_f32 v184, v184
    v_exp_f32 v185, v185
    v_exp_f32 v186, v186
    v_exp_f32 v187, v187
    v_cvt_pk_bf16_f32 v26, v180, v181
    v_cvt_pk_bf16_f32 v27, v182, v183
    v_mfma_f32_32x32x16_bf16 v[128:143], v[204:207], v[20:23], v[128:143]
    v_exp_f32 v188, v188
    v_exp_f32 v189, v189
    v_exp_f32 v190, v190
    v_exp_f32 v191, v191
    v_cvt_pk_bf16_f32 v28, v184, v185
    v_cvt_pk_bf16_f32 v29, v186, v187
    v_cvt_pk_bf16_f32 v30, v188, v189
    v_cvt_pk_bf16_f32 v31, v190, v191
    v_mfma_f32_32x32x16_bf16 v[176:191], v[208:211], v[72:75], 0
    v_exp_f32 v160, v160
    v_exp_f32 v161, v161
    v_exp_f32 v162, v162
    v_exp_f32 v163, v163
    v_mfma_f32_32x32x16_bf16 v[144:159], v[200:203], v[24:27], v[144:159]
    v_exp_f32 v164, v164
    v_exp_f32 v165, v165
    v_exp_f32 v166, v166
    v_exp_f32 v167, v167
    v_cvt_pk_bf16_f32 v16, v160, v161
    v_cvt_pk_bf16_f32 v17, v162, v163
    v_mfma_f32_32x32x16_bf16 v[176:191], v[212:215], v[76:79], v[176:191]
    v_exp_f32 v168, v168
    v_exp_f32 v169, v169
    v_exp_f32 v170, v170
    v_exp_f32 v171, v171
    v_cvt_pk_bf16_f32 v18, v164, v165
    v_cvt_pk_bf16_f32 v19, v166, v167
    v_mfma_f32_32x32x16_bf16 v[144:159], v[204:207], v[28:31], v[144:159]
    v_exp_f32 v172, v172
    v_exp_f32 v173, v173
    v_exp_f32 v174, v174
    v_exp_f32 v175, v175
    v_cvt_pk_bf16_f32 v20, v168, v169
    v_cvt_pk_bf16_f32 v21, v170, v171
    v_cvt_pk_bf16_f32 v22, v172, v173
    v_cvt_pk_bf16_f32 v23, v174, v175
    v_mfma_f32_32x32x16_bf16 v[160:175], v[208:211], v[80:83], 0
    s_waitcnt vmcnt(10)
    v_exp_f32 v176, v176
    v_exp_f32 v177, v177
    v_exp_f32 v178, v178
    v_exp_f32 v179, v179
    v_mfma_f32_32x32x16_bf16 v[96:111], v[216:219], v[16:19], v[96:111]
    buffer_load_dwordx4 v[200:203], v2, s[68:71], s13 offen offset:2048 sc1
    v_exp_f32 v180, v180
    v_exp_f32 v181, v181
    v_exp_f32 v182, v182
    v_exp_f32 v183, v183
    v_cvt_pk_bf16_f32 v24, v176, v177
    v_cvt_pk_bf16_f32 v25, v178, v179
    v_mfma_f32_32x32x16_bf16 v[160:175], v[212:215], v[84:87], v[160:175]
    buffer_load_dwordx4 v[204:207], v2, s[68:71], s13 offen offset:3072 sc1
    v_exp_f32 v184, v184
    v_exp_f32 v185, v185
    v_exp_f32 v186, v186
    v_exp_f32 v187, v187
    v_cvt_pk_bf16_f32 v26, v180, v181
    v_cvt_pk_bf16_f32 v27, v182, v183
    v_mfma_f32_32x32x16_bf16 v[96:111], v[220:223], v[20:23], v[96:111]
    s_add_u32 s13, s13, 4096
    v_exp_f32 v188, v188
    v_exp_f32 v189, v189
    v_exp_f32 v190, v190
    v_exp_f32 v191, v191
    v_cvt_pk_bf16_f32 v28, v184, v185
    v_cvt_pk_bf16_f32 v29, v186, v187
    v_cvt_pk_bf16_f32 v30, v188, v189
    v_cvt_pk_bf16_f32 v31, v190, v191
    v_mfma_f32_32x32x16_bf16 v[176:191], v[208:211], v[88:91], 0
    v_exp_f32 v160, v160
    v_exp_f32 v161, v161
    v_exp_f32 v162, v162
    v_exp_f32 v163, v163
    v_mfma_f32_32x32x16_bf16 v[112:127], v[216:219], v[24:27], v[112:127]
    v_exp_f32 v164, v164
    v_exp_f32 v165, v165
    v_exp_f32 v166, v166
    v_exp_f32 v167, v167
    v_cvt_pk_bf16_f32 v16, v160, v161
    v_cvt_pk_bf16_f32 v17, v162, v163
    v_mfma_f32_32x32x16_bf16 v[176:191], v[212:215], v[92:95], v[176:191]
    v_exp_f32 v168, v168
    v_exp_f32 v169, v169
    v_exp_f32 v170, v170
    v_exp_f32 v171, v171
    v_cvt_pk_bf16_f32 v18, v164, v165
    v_cvt_pk_bf16_f32 v19, v166, v167
    v_mfma_f32_32x32x16_bf16 v[112:127], v[220:223], v[28:31], v[112:127]
    s_waitcnt vmcnt(10)
    v_exp_f32 v172, v172
    v_exp_f32 v173, v173
    v_exp_f32 v174, v174
    v_exp_f32 v175, v175
    v_cvt_pk_bf16_f32 v20, v168, v169
    v_cvt_pk_bf16_f32 v21, v170, v171
    v_cvt_pk_bf16_f32 v22, v172, v173
    v_cvt_pk_bf16_f32 v23, v174, v175
    v_mfma_f32_32x32x16_bf16 v[160:175], v[224:227], v[64:67], 0
    buffer_load_dwordx4 v[208:211], v2, s[68:71], s13 offen offset:0 sc1
    v_exp_f32 v176, v176
    v_exp_f32 v177, v177
    v_exp_f32 v178, v178
    v_exp_f32 v179, v179
    v_mfma_f32_32x32x16_bf16 v[128:143], v[216:219], v[16:19], v[128:143]
    buffer_load_dwordx4 v[212:215], v2, s[68:71], s13 offen offset:1024 sc1
    v_exp_f32 v180, v180
    v_exp_f32 v181, v181
    v_exp_f32 v182, v182
    v_exp_f32 v183, v183
    v_cvt_pk_bf16_f32 v24, v176, v177
    v_cvt_pk_bf16_f32 v25, v178, v179
    v_mfma_f32_32x32x16_bf16 v[160:175], v[228:231], v[68:71], v[160:175]
    v_exp_f32 v184, v184
    v_exp_f32 v185, v185
    v_exp_f32 v186, v186
    v_exp_f32 v187, v187
    v_cvt_pk_bf16_f32 v26, v180, v181
    v_cvt_pk_bf16_f32 v27, v182, v183
    v_mfma_f32_32x32x16_bf16 v[128:143], v[220:223], v[20:23], v[128:143]
    v_exp_f32 v188, v188
    v_exp_f32 v189, v189
    v_exp_f32 v190, v190
    v_exp_f32 v191, v191
    v_cvt_pk_bf16_f32 v28, v184, v185
    v_cvt_pk_bf16_f32 v29, v186, v187
    v_cvt_pk_bf16_f32 v30, v188, v189
    v_cvt_pk_bf16_f32 v31, v190, v191
    v_mfma_f32_32x32x16_bf16 v[176:191], v[224:227], v[72:75], 0
    v_exp_f32 v160, v160
    v_exp_f32 v161, v161
    v_exp_f32 v162, v162
    v_exp_f32 v163, v163
    v_mfma_f32_32x32x16_bf16 v[144:159], v[216:219], v[24:27], v[144:159]
    v_exp_f32 v164, v164
    v_exp_f32 v165, v165
    v_exp_f32 v166, v166
    v_exp_f32 v167, v167
    v_cvt_pk_bf16_f32 v16, v160, v161
    v_cvt_pk_bf16_f32 v17, v162, v163
    v_mfma_f32_32x32x16_bf16 v[176:191], v[228:231], v[76:79], v[176:191]
    v_exp_f32 v168, v168
    v_exp_f32 v169, v169
    v_exp_f32 v170, v170
    v_exp_f32 v171, v171
    v_cvt_pk_bf16_f32 v18, v164, v165
    v_cvt_pk_bf16_f32 v19, v166, v167
    v_mfma_f32_32x32x16_bf16 v[144:159], v[220:223], v[28:31], v[144:159]
    v_exp_f32 v172, v172
    v_exp_f32 v173, v173
    v_exp_f32 v174, v174
    v_exp_f32 v175, v175
    v_cvt_pk_bf16_f32 v20, v168, v169
    v_cvt_pk_bf16_f32 v21, v170, v171
    v_cvt_pk_bf16_f32 v22, v172, v173
    v_cvt_pk_bf16_f32 v23, v174, v175
    v_mfma_f32_32x32x16_bf16 v[160:175], v[224:227], v[80:83], 0
    s_waitcnt vmcnt(10)
    v_exp_f32 v176, v176
    v_exp_f32 v177, v177
    v_exp_f32 v178, v178
    v_exp_f32 v179, v179
    v_mfma_f32_32x32x16_bf16 v[96:111], v[232:235], v[16:19], v[96:111]
    buffer_load_dwordx4 v[216:219], v2, s[68:71], s13 offen offset:2048 sc1
    v_exp_f32 v180, v180
    v_exp_f32 v181, v181
    v_exp_f32 v182, v182
    v_exp_f32 v183, v183
    v_cvt_pk_bf16_f32 v24, v176, v177
    v_cvt_pk_bf16_f32 v25, v178, v179
    v_mfma_f32_32x32x16_bf16 v[160:175], v[228:231], v[84:87], v[160:175]
    buffer_load_dwordx4 v[220:223], v2, s[68:71], s13 offen offset:3072 sc1
    v_exp_f32 v184, v184
    v_exp_f32 v185, v185
    v_exp_f32 v186, v186
    v_exp_f32 v187, v187
    v_cvt_pk_bf16_f32 v26, v180, v181
    v_cvt_pk_bf16_f32 v27, v182, v183
    v_mfma_f32_32x32x16_bf16 v[96:111], v[236:239], v[20:23], v[96:111]
    s_add_u32 s13, s13, 4096
    v_exp_f32 v188, v188
    v_exp_f32 v189, v189
    v_exp_f32 v190, v190
    v_exp_f32 v191, v191
    v_cvt_pk_bf16_f32 v28, v184, v185
    v_cvt_pk_bf16_f32 v29, v186, v187
    v_cvt_pk_bf16_f32 v30, v188, v189
    v_cvt_pk_bf16_f32 v31, v190, v191
    v_mfma_f32_32x32x16_bf16 v[176:191], v[224:227], v[88:91], 0
    v_exp_f32 v160, v160
    v_exp_f32 v161, v161
    v_exp_f32 v162, v162
    v_exp_f32 v163, v163
    v_mfma_f32_32x32x16_bf16 v[112:127], v[232:235], v[24:27], v[112:127]
    v_exp_f32 v164, v164
    v_exp_f32 v165, v165
    v_exp_f32 v166, v166
    v_exp_f32 v167, v167
    v_cvt_pk_bf16_f32 v16, v160, v161
    v_cvt_pk_bf16_f32 v17, v162, v163
    v_mfma_f32_32x32x16_bf16 v[176:191], v[228:231], v[92:95], v[176:191]
    v_exp_f32 v168, v168
    v_exp_f32 v169, v169
    v_exp_f32 v170, v170
    v_exp_f32 v171, v171
    v_cvt_pk_bf16_f32 v18, v164, v165
    v_cvt_pk_bf16_f32 v19, v166, v167
    v_mfma_f32_32x32x16_bf16 v[112:127], v[236:239], v[28:31], v[112:127]
    s_waitcnt vmcnt(10)
    v_exp_f32 v172, v172
    v_exp_f32 v173, v173
    v_exp_f32 v174, v174
    v_exp_f32 v175, v175
    v_cvt_pk_bf16_f32 v20, v168, v169
    v_cvt_pk_bf16_f32 v21, v170, v171
    v_cvt_pk_bf16_f32 v22, v172, v173
    v_cvt_pk_bf16_f32 v23, v174, v175
    v_mfma_f32_32x32x16_bf16 v[160:175], v[240:243], v[64:67], 0
    buffer_load_dwordx4 v[224:227], v2, s[68:71], s13 offen offset:0 sc1
    v_exp_f32 v176, v176
    v_exp_f32 v177, v177
    v_exp_f32 v178, v178
    v_exp_f32 v179, v179
    v_mfma_f32_32x32x16_bf16 v[128:143], v[232:235], v[16:19], v[128:143]
    buffer_load_dwordx4 v[228:231], v2, s[68:71], s13 offen offset:1024 sc1
    v_exp_f32 v180, v180
    v_exp_f32 v181, v181
    v_exp_f32 v182, v182
    v_exp_f32 v183, v183
    v_cvt_pk_bf16_f32 v24, v176, v177
    v_cvt_pk_bf16_f32 v25, v178, v179
    v_mfma_f32_32x32x16_bf16 v[160:175], v[244:247], v[68:71], v[160:175]
    v_exp_f32 v184, v184
    v_exp_f32 v185, v185
    v_exp_f32 v186, v186
    v_exp_f32 v187, v187
    v_cvt_pk_bf16_f32 v26, v180, v181
    v_cvt_pk_bf16_f32 v27, v182, v183
    v_mfma_f32_32x32x16_bf16 v[128:143], v[236:239], v[20:23], v[128:143]
    v_exp_f32 v188, v188
    v_exp_f32 v189, v189
    v_exp_f32 v190, v190
    v_exp_f32 v191, v191
    v_cvt_pk_bf16_f32 v28, v184, v185
    v_cvt_pk_bf16_f32 v29, v186, v187
    v_cvt_pk_bf16_f32 v30, v188, v189
    v_cvt_pk_bf16_f32 v31, v190, v191
    v_mfma_f32_32x32x16_bf16 v[176:191], v[240:243], v[72:75], 0
    v_exp_f32 v160, v160
    v_exp_f32 v161, v161
    v_exp_f32 v162, v162
    v_exp_f32 v163, v163
    v_mfma_f32_32x32x16_bf16 v[144:159], v[232:235], v[24:27], v[144:159]
    v_exp_f32 v164, v164
    v_exp_f32 v165, v165
    v_exp_f32 v166, v166
    v_exp_f32 v167, v167
    v_cvt_pk_bf16_f32 v16, v160, v161
    v_cvt_pk_bf16_f32 v17, v162, v163
    v_mfma_f32_32x32x16_bf16 v[176:191], v[244:247], v[76:79], v[176:191]
    v_exp_f32 v168, v168
    v_exp_f32 v169, v169
    v_exp_f32 v170, v170
    v_exp_f32 v171, v171
    v_cvt_pk_bf16_f32 v18, v164, v165
    v_cvt_pk_bf16_f32 v19, v166, v167
    v_mfma_f32_32x32x16_bf16 v[144:159], v[236:239], v[28:31], v[144:159]
    v_exp_f32 v172, v172
    v_exp_f32 v173, v173
    v_exp_f32 v174, v174
    v_exp_f32 v175, v175
    v_cvt_pk_bf16_f32 v20, v168, v169
    v_cvt_pk_bf16_f32 v21, v170, v171
    v_cvt_pk_bf16_f32 v22, v172, v173
    v_cvt_pk_bf16_f32 v23, v174, v175
    v_mfma_f32_32x32x16_bf16 v[160:175], v[240:243], v[80:83], 0
    s_waitcnt vmcnt(10)
    v_exp_f32 v176, v176
    v_exp_f32 v177, v177
    v_exp_f32 v178, v178
    v_exp_f32 v179, v179
    v_mfma_f32_32x32x16_bf16 v[96:111], v[248:251], v[16:19], v[96:111]
    buffer_load_dwordx4 v[232:235], v2, s[68:71], s13 offen offset:2048 sc1
    v_exp_f32 v180, v180
    v_exp_f32 v181, v181
    v_exp_f32 v182, v182
    v_exp_f32 v183, v183
    v_cvt_pk_bf16_f32 v24, v176, v177
    v_cvt_pk_bf16_f32 v25, v178, v179
    v_mfma_f32_32x32x16_bf16 v[160:175], v[244:247], v[84:87], v[160:175]
    buffer_load_dwordx4 v[236:239], v2, s[68:71], s13 offen offset:3072 sc1
    v_exp_f32 v184, v184
    v_exp_f32 v185, v185
    v_exp_f32 v186, v186
    v_exp_f32 v187, v187
    v_cvt_pk_bf16_f32 v26, v180, v181
    v_cvt_pk_bf16_f32 v27, v182, v183
    v_mfma_f32_32x32x16_bf16 v[96:111], v[252:255], v[20:23], v[96:111]
    s_add_u32 s13, s13, 4096
    v_exp_f32 v188, v188
    v_exp_f32 v189, v189
    v_exp_f32 v190, v190
    v_exp_f32 v191, v191
    v_cvt_pk_bf16_f32 v28, v184, v185
    v_cvt_pk_bf16_f32 v29, v186, v187
    v_cvt_pk_bf16_f32 v30, v188, v189
    v_cvt_pk_bf16_f32 v31, v190, v191
    v_mfma_f32_32x32x16_bf16 v[176:191], v[240:243], v[88:91], 0
    v_exp_f32 v160, v160
    v_exp_f32 v161, v161
    v_exp_f32 v162, v162
    v_exp_f32 v163, v163
    v_mfma_f32_32x32x16_bf16 v[112:127], v[248:251], v[24:27], v[112:127]
    v_exp_f32 v164, v164
    v_exp_f32 v165, v165
    v_exp_f32 v166, v166
    v_exp_f32 v167, v167
    v_cvt_pk_bf16_f32 v16, v160, v161
    v_cvt_pk_bf16_f32 v17, v162, v163
    v_mfma_f32_32x32x16_bf16 v[176:191], v[244:247], v[92:95], v[176:191]
    v_exp_f32 v168, v168
    v_exp_f32 v169, v169
    v_exp_f32 v170, v170
    v_exp_f32 v171, v171
    v_cvt_pk_bf16_f32 v18, v164, v165
    v_cvt_pk_bf16_f32 v19, v166, v167
    v_mfma_f32_32x32x16_bf16 v[112:127], v[252:255], v[28:31], v[112:127]
    s_waitcnt vmcnt(10)
    v_exp_f32 v172, v172
    v_exp_f32 v173, v173
    v_exp_f32 v174, v174
    v_exp_f32 v175, v175
    v_cvt_pk_bf16_f32 v20, v168, v169
    v_cvt_pk_bf16_f32 v21, v170, v171
    v_cvt_pk_bf16_f32 v22, v172, v173
    v_cvt_pk_bf16_f32 v23, v174, v175
    v_mfma_f32_32x32x16_bf16 v[160:175], v[192:195], v[64:67], 0
    buffer_load_dwordx4 v[240:243], v2, s[68:71], s13 offen offset:0 sc1
    v_exp_f32 v176, v176
    v_exp_f32 v177, v177
    v_exp_f32 v178, v178
    v_exp_f32 v179, v179
    v_mfma_f32_32x32x16_bf16 v[128:143], v[248:251], v[16:19], v[128:143]
    buffer_load_dwordx4 v[244:247], v2, s[68:71], s13 offen offset:1024 sc1
    v_exp_f32 v180, v180
    v_exp_f32 v181, v181
    v_exp_f32 v182, v182
    v_exp_f32 v183, v183
    v_cvt_pk_bf16_f32 v24, v176, v177
    v_cvt_pk_bf16_f32 v25, v178, v179
    v_mfma_f32_32x32x16_bf16 v[160:175], v[196:199], v[68:71], v[160:175]
    v_exp_f32 v184, v184
    v_exp_f32 v185, v185
    v_exp_f32 v186, v186
    v_exp_f32 v187, v187
    v_cvt_pk_bf16_f32 v26, v180, v181
    v_cvt_pk_bf16_f32 v27, v182, v183
    v_mfma_f32_32x32x16_bf16 v[128:143], v[252:255], v[20:23], v[128:143]
    s_cmp_lt_u32 s13, 61440
    v_exp_f32 v188, v188
    v_exp_f32 v189, v189
    v_exp_f32 v190, v190
    v_exp_f32 v191, v191
    v_cvt_pk_bf16_f32 v28, v184, v185
    v_cvt_pk_bf16_f32 v29, v186, v187
    v_cvt_pk_bf16_f32 v30, v188, v189
    v_cvt_pk_bf16_f32 v31, v190, v191
    v_mfma_f32_32x32x16_bf16 v[176:191], v[192:195], v[72:75], 0
    s_cbranch_scc1 L_attn
    v_exp_f32 v160, v160
    v_exp_f32 v161, v161
    v_exp_f32 v162, v162
    v_exp_f32 v163, v163
    v_mfma_f32_32x32x16_bf16 v[144:159], v[248:251], v[24:27], v[144:159]
    v_exp_f32 v164, v164
    v_exp_f32 v165, v165
    v_exp_f32 v166, v166
    v_exp_f32 v167, v167
    v_cvt_pk_bf16_f32 v16, v160, v161
    v_cvt_pk_bf16_f32 v17, v162, v163
    v_mfma_f32_32x32x16_bf16 v[176:191], v[196:199], v[76:79], v[176:191]
    v_exp_f32 v168, v168
    v_exp_f32 v169, v169
    v_exp_f32 v170, v170
    v_exp_f32 v171, v171
    v_cvt_pk_bf16_f32 v18, v164, v165
    v_cvt_pk_bf16_f32 v19, v166, v167
    v_mfma_f32_32x32x16_bf16 v[144:159], v[252:255], v[28:31], v[144:159]
    v_exp_f32 v172, v172
    v_exp_f32 v173, v173
    v_exp_f32 v174, v174
    v_exp_f32 v175, v175
    v_cvt_pk_bf16_f32 v20, v168, v169
    v_cvt_pk_bf16_f32 v21, v170, v171
    v_cvt_pk_bf16_f32 v22, v172, v173
    v_cvt_pk_bf16_f32 v23, v174, v175
    s_waitcnt vmcnt(8)
    v_mfma_f32_32x32x16_bf16 v[160:175], v[208:211], v[64:67], 0
    v_exp_f32 v176, v176
    v_exp_f32 v177, v177
    v_exp_f32 v178, v178
    v_exp_f32 v179, v179
    v_mfma_f32_32x32x16_bf16 v[96:111], v[200:203], v[16:19], v[96:111]
    buffer_load_dwordx4 v[248:251], v2, s[68:71], s13 offen offset:2048 sc1
    v_exp_f32 v180, v180
    v_exp_f32 v181, v181
    v_exp_f32 v182, v182
    v_exp_f32 v183, v183
    v_cvt_pk_bf16_f32 v24, v176, v177
    v_cvt_pk_bf16_f32 v25, v178, v179
    v_mfma_f32_32x32x16_bf16 v[160:175], v[212:215], v[68:71], v[160:175]
    buffer_load_dwordx4 v[252:255], v2, s[68:71], s13 offen offset:3072 sc1
    v_exp_f32 v184, v184
    v_exp_f32 v185, v185
    v_exp_f32 v186, v186
    v_exp_f32 v187, v187
    v_cvt_pk_bf16_f32 v26, v180, v181
    v_cvt_pk_bf16_f32 v27, v182, v183
    v_mfma_f32_32x32x16_bf16 v[96:111], v[204:207], v[20:23], v[96:111]
    v_exp_f32 v188, v188
    v_exp_f32 v189, v189
    v_exp_f32 v190, v190
    v_exp_f32 v191, v191
    v_cvt_pk_bf16_f32 v28, v184, v185
    v_cvt_pk_bf16_f32 v29, v186, v187
    v_cvt_pk_bf16_f32 v30, v188, v189
    v_cvt_pk_bf16_f32 v31, v190, v191
    v_mfma_f32_32x32x16_bf16 v[176:191], v[208:211], v[72:75], 0
    v_exp_f32 v160, v160
    v_exp_f32 v161, v161
    v_exp_f32 v162, v162
    v_exp_f32 v163, v163
    v_mfma_f32_32x32x16_bf16 v[112:127], v[200:203], v[24:27], v[112:127]
    v_exp_f32 v164, v164
    v_exp_f32 v165, v165
    v_exp_f32 v166, v166
    v_exp_f32 v167, v167
    v_cvt_pk_bf16_f32 v16, v160, v161
    v_cvt_pk_bf16_f32 v17, v162, v163
    v_mfma_f32_32x32x16_bf16 v[176:191], v[212:215], v[76:79], v[176:191]
    v_exp_f32 v168, v168
    v_exp_f32 v169, v169
    v_exp_f32 v170, v170
    v_exp_f32 v171, v171
    v_cvt_pk_bf16_f32 v18, v164, v165
    v_cvt_pk_bf16_f32 v19, v166, v167
    v_mfma_f32_32x32x16_bf16 v[112:127], v[204:207], v[28:31], v[112:127]
    v_exp_f32 v172, v172
    v_exp_f32 v173, v173
    v_exp_f32 v174, v174
    v_exp_f32 v175, v175
    v_cvt_pk_bf16_f32 v20, v168, v169
    v_cvt_pk_bf16_f32 v21, v170, v171
    v_cvt_pk_bf16_f32 v22, v172, v173
    v_cvt_pk_bf16_f32 v23, v174, v175
    s_waitcnt vmcnt(6)
    v_mfma_f32_32x32x16_bf16 v[160:175], v[224:227], v[64:67], 0
    v_exp_f32 v176, v176
    v_exp_f32 v177, v177
    v_exp_f32 v178, v178
    v_exp_f32 v179, v179
    v_mfma_f32_32x32x16_bf16 v[96:111], v[216:219], v[16:19], v[96:111]
    v_exp_f32 v180, v180
    v_exp_f32 v181, v181
    v_exp_f32 v182, v182
    v_exp_f32 v183, v183
    v_cvt_pk_bf16_f32 v24, v176, v177
    v_cvt_pk_bf16_f32 v25, v178, v179
    v_mfma_f32_32x32x16_bf16 v[160:175], v[228:231], v[68:71], v[160:175]
    v_exp_f32 v184, v184
    v_exp_f32 v185, v185
    v_exp_f32 v186, v186
    v_exp_f32 v187, v187
    v_cvt_pk_bf16_f32 v26, v180, v181
    v_cvt_pk_bf16_f32 v27, v182, v183
    v_mfma_f32_32x32x16_bf16 v[96:111], v[220:223], v[20:23], v[96:111]
    v_exp_f32 v188, v188
    v_exp_f32 v189, v189
    v_exp_f32 v190, v190
    v_exp_f32 v191, v191
    v_cvt_pk_bf16_f32 v28, v184, v185
    v_cvt_pk_bf16_f32 v29, v186, v187
    v_cvt_pk_bf16_f32 v30, v188, v189
    v_cvt_pk_bf16_f32 v31, v190, v191
    v_mfma_f32_32x32x16_bf16 v[176:191], v[224:227], v[72:75], 0
    v_exp_f32 v160, v160
    v_exp_f32 v161, v161
    v_exp_f32 v162, v162
    v_exp_f32 v163, v163
    v_mfma_f32_32x32x16_bf16 v[112:127], v[216:219], v[24:27], v[112:127]
    v_exp_f32 v164, v164
    v_exp_f32 v165, v165
    v_exp_f32 v166, v166
    v_exp_f32 v167, v167
    v_cvt_pk_bf16_f32 v16, v160, v161
    v_cvt_pk_bf16_f32 v17, v162, v163
    v_mfma_f32_32x32x16_bf16 v[176:191], v[228:231], v[76:79], v[176:191]
    v_exp_f32 v168, v168
    v_exp_f32 v169, v169
    v_exp_f32 v170, v170
    v_exp_f32 v171, v171
    v_cvt_pk_bf16_f32 v18, v164, v165
    v_cvt_pk_bf16_f32 v19, v166, v167
    v_mfma_f32_32x32x16_bf16 v[112:127], v[220:223], v[28:31], v[112:127]
    v_exp_f32 v172, v172
    v_exp_f32 v173, v173
    v_exp_f32 v174, v174
    v_exp_f32 v175, v175
    v_cvt_pk_bf16_f32 v20, v168, v169
    v_cvt_pk_bf16_f32 v21, v170, v171
    v_cvt_pk_bf16_f32 v22, v172, v173
    v_cvt_pk_bf16_f32 v23, v174, v175
    s_waitcnt vmcnt(2)
    v_mfma_f32_32x32x16_bf16 v[160:175], v[240:243], v[64:67], 0
    s_lshl_b32 s5, s9, 4
    s_add_u32 s5, s5, s8
    v_exp_f32 v176, v176
    v_exp_f32 v177, v177
    v_exp_f32 v178, v178
    v_exp_f32 v179, v179
    v_mfma_f32_32x32x16_bf16 v[96:111], v[232:235], v[16:19], v[96:111]
    s_lshl_b32 s6, s5, 11
    s_add_u32 s6, s6, 0x200000
    v_exp_f32 v180, v180
    v_exp_f32 v181, v181
    v_exp_f32 v182, v182
    v_exp_f32 v183, v183
    v_cvt_pk_bf16_f32 v24, v176, v177
    v_cvt_pk_bf16_f32 v25, v178, v179
    v_mfma_f32_32x32x16_bf16 v[160:175], v[244:247], v[68:71], v[160:175]
    s_lshl_b32 s7, s5, 7
    s_add_u32 s7, s7, 0x1000c
    v_exp_f32 v184, v184
    v_exp_f32 v185, v185
    v_exp_f32 v186, v186
    v_exp_f32 v187, v187
    v_cvt_pk_bf16_f32 v26, v180, v181
    v_cvt_pk_bf16_f32 v27, v182, v183
    v_mfma_f32_32x32x16_bf16 v[96:111], v[236:239], v[20:23], v[96:111]
    s_and_b32 s5, s4, 0xbfff0000
    s_mov_b32 s10, 0x07060100
    s_mov_b32 s11, 0x07060302
    v_exp_f32 v188, v188
    v_exp_f32 v189, v189
    v_exp_f32 v190, v190
    v_exp_f32 v191, v191
    v_cvt_pk_bf16_f32 v28, v184, v185
    v_cvt_pk_bf16_f32 v29, v186, v187
    v_cvt_pk_bf16_f32 v30, v188, v189
    v_cvt_pk_bf16_f32 v31, v190, v191
    v_mfma_f32_32x32x16_bf16 v[176:191], v[240:243], v[72:75], 0
    v_mov_b32 v40, s5
    v_mov_b32 v41, 0x03020100
    v_exp_f32 v160, v160
    v_exp_f32 v161, v161
    v_exp_f32 v162, v162
    v_exp_f32 v163, v163
    v_mfma_f32_32x32x16_bf16 v[112:127], v[232:235], v[24:27], v[112:127]
    v_mov_b32 v42, 0x07060100
    v_mov_b32 v43, 0x07060302
    v_exp_f32 v164, v164
    v_exp_f32 v165, v165
    v_exp_f32 v166, v166
    v_exp_f32 v167, v167
    v_cvt_pk_bf16_f32 v16, v160, v161
    v_cvt_pk_bf16_f32 v17, v162, v163
    v_mfma_f32_32x32x16_bf16 v[176:191], v[244:247], v[76:79], v[176:191]
    v_cndmask_b32 v41, v41, v42, s[14:15]
    v_exp_f32 v168, v168
    v_exp_f32 v169, v169
    v_exp_f32 v170, v170
    v_exp_f32 v171, v171
    v_cvt_pk_bf16_f32 v18, v164, v165
    v_cvt_pk_bf16_f32 v19, v166, v167
    v_mfma_f32_32x32x16_bf16 v[112:127], v[236:239], v[28:31], v[112:127]
    v_cndmask_b32 v42, v42, v43, s[14:15]
    v_exp_f32 v172, v172
    v_exp_f32 v173, v173
    v_exp_f32 v174, v174
    v_exp_f32 v175, v175
    v_cvt_pk_bf16_f32 v20, v168, v169
    v_cvt_pk_bf16_f32 v21, v170, v171
    v_cvt_pk_bf16_f32 v22, v172, v173
    v_cvt_pk_bf16_f32 v23, v174, v175
    v_mfma_f32_32x32x16_bf16 v[160:175], v[192:195], v[80:83], 0
    s_waitcnt vmcnt(0)
    v_exp_f32 v176, v176
    v_exp_f32 v177, v177
    v_exp_f32 v178, v178
    v_exp_f32 v179, v179
    v_mfma_f32_32x32x16_bf16 v[96:111], v[248:251], v[16:19], v[96:111]
    v_exp_f32 v180, v180
    v_exp_f32 v181, v181
    v_exp_f32 v182, v182
    v_exp_f32 v183, v183
    v_cvt_pk_bf16_f32 v24, v176, v177
    v_cvt_pk_bf16_f32 v25, v178, v179
    v_mfma_f32_32x32x16_bf16 v[160:175], v[196:199], v[84:87], v[160:175]
    v_exp_f32 v184, v184
    v_exp_f32 v185, v185
    v_exp_f32 v186, v186
    v_exp_f32 v187, v187
    v_cvt_pk_bf16_f32 v26, v180, v181
    v_cvt_pk_bf16_f32 v27, v182, v183
    v_mfma_f32_32x32x16_bf16 v[96:111], v[252:255], v[20:23], v[96:111]
    v_exp_f32 v188, v188
    v_exp_f32 v189, v189
    v_exp_f32 v190, v190
    v_exp_f32 v191, v191
    v_cvt_pk_bf16_f32 v28, v184, v185
    v_cvt_pk_bf16_f32 v29, v186, v187
    v_cvt_pk_bf16_f32 v30, v188, v189
    v_cvt_pk_bf16_f32 v31, v190, v191
    v_mfma_f32_32x32x16_bf16 v[176:191], v[208:211], v[80:83], 0
    v_exp_f32 v160, v160
    v_exp_f32 v161, v161
    v_exp_f32 v162, v162
    v_exp_f32 v163, v163
    v_mfma_f32_32x32x16_bf16 v[112:127], v[248:251], v[24:27], v[112:127]
    ds_write_b128 v8, v[96:99] offset:0
    v_exp_f32 v164, v164
    v_exp_f32 v165, v165
    v_exp_f32 v166, v166
    v_exp_f32 v167, v167
    v_cvt_pk_bf16_f32 v16, v160, v161
    v_cvt_pk_bf16_f32 v17, v162, v163
    v_mfma_f32_32x32x16_bf16 v[176:191], v[212:215], v[84:87], v[176:191]
    ds_write_b128 v8, v[100:103] offset:1024
    v_exp_f32 v168, v168
    v_exp_f32 v169, v169
    v_exp_f32 v170, v170
    v_exp_f32 v171, v171
    v_cvt_pk_bf16_f32 v18, v164, v165
    v_cvt_pk_bf16_f32 v19, v166, v167
    v_mfma_f32_32x32x16_bf16 v[112:127], v[252:255], v[28:31], v[112:127]
    ds_write_b128 v8, v[104:107] offset:2048
    v_exp_f32 v172, v172
    v_exp_f32 v173, v173
    v_exp_f32 v174, v174
    v_exp_f32 v175, v175
    v_cvt_pk_bf16_f32 v20, v168, v169
    v_cvt_pk_bf16_f32 v21, v170, v171
    v_cvt_pk_bf16_f32 v22, v172, v173
    v_cvt_pk_bf16_f32 v23, v174, v175
    ds_write_b128 v8, v[108:111] offset:3072
    v_mfma_f32_32x32x16_bf16 v[160:175], v[224:227], v[80:83], 0
    v_exp_f32 v176, v176
    v_exp_f32 v177, v177
    v_exp_f32 v178, v178
    v_exp_f32 v179, v179
    v_mfma_f32_32x32x16_bf16 v[128:143], v[200:203], v[16:19], v[128:143]
    ds_write_b128 v9, v[112:115] offset:0
    v_exp_f32 v180, v180
    v_exp_f32 v181, v181
    v_exp_f32 v182, v182
    v_exp_f32 v183, v183
    v_cvt_pk_bf16_f32 v24, v176, v177
    v_cvt_pk_bf16_f32 v25, v178, v179
    v_mfma_f32_32x32x16_bf16 v[160:175], v[228:231], v[84:87], v[160:175]
    ds_write_b128 v9, v[116:119] offset:1024
    v_exp_f32 v184, v184
    v_exp_f32 v185, v185
    v_exp_f32 v186, v186
    v_exp_f32 v187, v187
    v_cvt_pk_bf16_f32 v26, v180, v181
    v_cvt_pk_bf16_f32 v27, v182, v183
    v_mfma_f32_32x32x16_bf16 v[128:143], v[204:207], v[20:23], v[128:143]
    ds_write_b128 v9, v[120:123] offset:2048
    v_exp_f32 v188, v188
    v_exp_f32 v189, v189
    v_exp_f32 v190, v190
    v_exp_f32 v191, v191
    v_cvt_pk_bf16_f32 v28, v184, v185
    v_cvt_pk_bf16_f32 v29, v186, v187
    v_cvt_pk_bf16_f32 v30, v188, v189
    v_cvt_pk_bf16_f32 v31, v190, v191
    ds_write_b128 v9, v[124:127] offset:3072
    v_mfma_f32_32x32x16_bf16 v[176:191], v[240:243], v[80:83], 0
    v_exp_f32 v160, v160
    v_exp_f32 v161, v161
    v_exp_f32 v162, v162
    v_exp_f32 v163, v163
    v_mfma_f32_32x32x16_bf16 v[128:143], v[216:219], v[24:27], v[128:143]
    v_exp_f32 v164, v164
    v_exp_f32 v165, v165
    v_exp_f32 v166, v166
    v_exp_f32 v167, v167
    v_cvt_pk_bf16_f32 v16, v160, v161
    v_cvt_pk_bf16_f32 v17, v162, v163
    v_mfma_f32_32x32x16_bf16 v[176:191], v[244:247], v[84:87], v[176:191]
    v_exp_f32 v168, v168
    v_exp_f32 v169, v169
    v_exp_f32 v170, v170
    v_exp_f32 v171, v171
    v_cvt_pk_bf16_f32 v18, v164, v165
    v_cvt_pk_bf16_f32 v19, v166, v167
    v_mfma_f32_32x32x16_bf16 v[128:143], v[220:223], v[28:31], v[128:143]
    v_exp_f32 v172, v172
    v_exp_f32 v173, v173
    v_exp_f32 v174, v174
    v_exp_f32 v175, v175
    v_cvt_pk_bf16_f32 v20, v168, v169
    v_cvt_pk_bf16_f32 v21, v170, v171
    v_cvt_pk_bf16_f32 v22, v172, v173
    v_cvt_pk_bf16_f32 v23, v174, v175
    v_mfma_f32_32x32x16_bf16 v[160:175], v[192:195], v[88:91], 0
    v_exp_f32 v176, v176
    v_exp_f32 v177, v177
    v_exp_f32 v178, v178
    v_exp_f32 v179, v179
    v_mfma_f32_32x32x16_bf16 v[128:143], v[232:235], v[16:19], v[128:143]
    v_exp_f32 v180, v180
    v_exp_f32 v181, v181
    v_exp_f32 v182, v182
    v_exp_f32 v183, v183
    v_cvt_pk_bf16_f32 v24, v176, v177
    v_cvt_pk_bf16_f32 v25, v178, v179
    v_mfma_f32_32x32x16_bf16 v[160:175], v[196:199], v[92:95], v[160:175]
    v_exp_f32 v184, v184
    v_exp_f32 v185, v185
    v_exp_f32 v186, v186
    v_exp_f32 v187, v187
    v_cvt_pk_bf16_f32 v26, v180, v181
    v_cvt_pk_bf16_f32 v27, v182, v183
    v_mfma_f32_32x32x16_bf16 v[128:143], v[236:239], v[20:23], v[128:143]
    v_exp_f32 v188, v188
    v_exp_f32 v189, v189
    v_exp_f32 v190, v190
    v_exp_f32 v191, v191
    v_cvt_pk_bf16_f32 v28, v184, v185
    v_cvt_pk_bf16_f32 v29, v186, v187
    v_cvt_pk_bf16_f32 v30, v188, v189
    v_cvt_pk_bf16_f32 v31, v190, v191
    v_mfma_f32_32x32x16_bf16 v[176:191], v[208:211], v[88:91], 0
    v_exp_f32 v160, v160
    v_exp_f32 v161, v161
    v_exp_f32 v162, v162
    v_exp_f32 v163, v163
    v_mfma_f32_32x32x16_bf16 v[128:143], v[248:251], v[24:27], v[128:143]
    v_exp_f32 v164, v164
    v_exp_f32 v165, v165
    v_exp_f32 v166, v166
    v_exp_f32 v167, v167
    v_cvt_pk_bf16_f32 v16, v160, v161
    v_cvt_pk_bf16_f32 v17, v162, v163
    v_mfma_f32_32x32x16_bf16 v[176:191], v[212:215], v[92:95], v[176:191]
    v_exp_f32 v168, v168
    v_exp_f32 v169, v169
    v_exp_f32 v170, v170
    v_exp_f32 v171, v171
    v_cvt_pk_bf16_f32 v18, v164, v165
    v_cvt_pk_bf16_f32 v19, v166, v167
    v_mfma_f32_32x32x16_bf16 v[128:143], v[252:255], v[28:31], v[128:143]
    v_exp_f32 v172, v172
    v_exp_f32 v173, v173
    v_exp_f32 v174, v174
    v_exp_f32 v175, v175
    v_cvt_pk_bf16_f32 v20, v168, v169
    v_cvt_pk_bf16_f32 v21, v170, v171
    v_cvt_pk_bf16_f32 v22, v172, v173
    v_cvt_pk_bf16_f32 v23, v174, v175
    v_mfma_f32_32x32x16_bf16 v[160:175], v[224:227], v[88:91], 0
    v_exp_f32 v176, v176
    v_exp_f32 v177, v177
    v_exp_f32 v178, v178
    v_exp_f32 v179, v179
    v_mfma_f32_32x32x16_bf16 v[144:159], v[200:203], v[16:19], v[144:159]
    ds_write_b128 v10, v[128:131] offset:0
    ds_write_b128 v10, v[132:135] offset:1024
    v_exp_f32 v180, v180
    v_exp_f32 v181, v181
    v_exp_f32 v182, v182
    v_exp_f32 v183, v183
    v_cvt_pk_bf16_f32 v24, v176, v177
    v_cvt_pk_bf16_f32 v25, v178, v179
    v_mfma_f32_32x32x16_bf16 v[160:175], v[228:231], v[92:95], v[160:175]
    ds_write_b128 v10, v[136:139] offset:2048
    ds_write_b128 v10, v[140:143] offset:3072
    v_exp_f32 v184, v184
    v_exp_f32 v185, v185
    v_exp_f32 v186, v186
    v_exp_f32 v187, v187
    v_cvt_pk_bf16_f32 v26, v180, v181
    v_cvt_pk_bf16_f32 v27, v182, v183
    v_mfma_f32_32x32x16_bf16 v[144:159], v[204:207], v[20:23], v[144:159]
    v_exp_f32 v188, v188
    v_exp_f32 v189, v189
    v_exp_f32 v190, v190
    v_exp_f32 v191, v191
    v_cvt_pk_bf16_f32 v28, v184, v185
    v_cvt_pk_bf16_f32 v29, v186, v187
    v_cvt_pk_bf16_f32 v30, v188, v189
    v_cvt_pk_bf16_f32 v31, v190, v191
    s_waitcnt lgkmcnt(0)
    s_barrier
    v_mfma_f32_32x32x16_bf16 v[176:191], v[240:243], v[88:91], 0
    ds_read_b128 v[96:99], v11 offset:0
    ds_read_b128 v[112:115], v11 offset:4096
    ds_read_b128 v[100:103], v11 offset:1024
    ds_read_b128 v[116:119], v11 offset:5120
    v_exp_f32 v160, v160
    v_exp_f32 v161, v161
    v_exp_f32 v162, v162
    v_exp_f32 v163, v163
    v_mfma_f32_32x32x16_bf16 v[144:159], v[216:219], v[24:27], v[144:159]
    ds_read_b128 v[104:107], v11 offset:2048
    ds_read_b128 v[120:123], v11 offset:6144
    ds_read_b128 v[108:111], v11 offset:3072
    ds_read_b128 v[124:127], v11 offset:7168
    v_exp_f32 v164, v164
    v_exp_f32 v165, v165
    v_exp_f32 v166, v166
    v_exp_f32 v167, v167
    v_cvt_pk_bf16_f32 v16, v160, v161
    v_cvt_pk_bf16_f32 v17, v162, v163
    v_mfma_f32_32x32x16_bf16 v[176:191], v[244:247], v[92:95], v[176:191]
    ds_read_b128 v[128:131], v11 offset:8192
    ds_read_b128 v[132:135], v11 offset:9216
    ds_read_b128 v[136:139], v11 offset:10240
    ds_read_b128 v[140:143], v11 offset:11264
    v_exp_f32 v168, v168
    v_exp_f32 v169, v169
    v_exp_f32 v170, v170
    v_exp_f32 v171, v171
    v_cvt_pk_bf16_f32 v18, v164, v165
    v_cvt_pk_bf16_f32 v19, v166, v167
    v_mfma_f32_32x32x16_bf16 v[144:159], v[220:223], v[28:31], v[144:159]
    v_exp_f32 v172, v172
    v_exp_f32 v173, v173
    v_exp_f32 v174, v174
    v_exp_f32 v175, v175
    v_cvt_pk_bf16_f32 v20, v168, v169
    v_cvt_pk_bf16_f32 v21, v170, v171
    v_cvt_pk_bf16_f32 v22, v172, v173
    v_cvt_pk_bf16_f32 v23, v174, v175
    s_waitcnt lgkmcnt(4)
    v_pk_add_f32 v[96:97], v[96:97], v[112:113]
    v_pk_add_f32 v[98:99], v[98:99], v[114:115]
    v_pk_add_f32 v[100:101], v[100:101], v[116:117]
    v_pk_add_f32 v[102:103], v[102:103], v[118:119]
    v_pk_add_f32 v[104:105], v[104:105], v[120:121]
    v_pk_add_f32 v[106:107], v[106:107], v[122:123]
    v_pk_add_f32 v[108:109], v[108:109], v[124:125]
    v_pk_add_f32 v[110:111], v[110:111], v[126:127]
    v_exp_f32 v176, v176
    v_exp_f32 v177, v177
    v_exp_f32 v178, v178
    v_exp_f32 v179, v179
    v_mfma_f32_32x32x16_bf16 v[144:159], v[232:235], v[16:19], v[144:159]
    s_waitcnt lgkmcnt(0)
    v_pk_add_f32 v[96:97], v[96:97], v[128:129]
    v_pk_add_f32 v[98:99], v[98:99], v[130:131]
    v_pk_add_f32 v[100:101], v[100:101], v[132:133]
    v_pk_add_f32 v[102:103], v[102:103], v[134:135]
    v_exp_f32 v180, v180
    v_exp_f32 v181, v181
    v_exp_f32 v182, v182
    v_exp_f32 v183, v183
    v_cvt_pk_bf16_f32 v24, v176, v177
    v_cvt_pk_bf16_f32 v25, v178, v179
    v_pk_add_f32 v[104:105], v[104:105], v[136:137]
    v_pk_add_f32 v[106:107], v[106:107], v[138:139]
    v_pk_add_f32 v[108:109], v[108:109], v[140:141]
    v_pk_add_f32 v[110:111], v[110:111], v[142:143]
    v_exp_f32 v184, v184
    v_exp_f32 v185, v185
    v_exp_f32 v186, v186
    v_exp_f32 v187, v187
    v_cvt_pk_bf16_f32 v26, v180, v181
    v_cvt_pk_bf16_f32 v27, v182, v183
    v_mfma_f32_32x32x16_bf16 v[144:159], v[236:239], v[20:23], v[144:159]
    s_mov_b32 s12, 0x21800000
    s_mov_b32 s13, 0x5d800000
    v_exp_f32 v188, v188
    v_exp_f32 v189, v189
    v_exp_f32 v190, v190
    v_exp_f32 v191, v191
    v_cvt_pk_bf16_f32 v28, v184, v185
    v_cvt_pk_bf16_f32 v29, v186, v187
    v_cvt_pk_bf16_f32 v30, v188, v189
    v_cvt_pk_bf16_f32 v31, v190, v191
    v_mfma_f32_32x32x16_bf16 v[144:159], v[248:251], v[24:27], v[144:159]
    s_nop 0
    v_mfma_f32_32x32x16_bf16 v[144:159], v[252:255], v[28:31], v[144:159]
    v_mov_b32 v7, s4
    s_mov_b32 exec_lo, 1
    s_mov_b32 exec_hi, 0
    buffer_store_dword v7, off, s[56:59], s7
    s_mov_b64 exec, -1
    s_nop 6
    v_pk_add_f32 v[144:145], v[144:145], v[96:97]
    v_pk_add_f32 v[146:147], v[146:147], v[98:99]
    v_pk_add_f32 v[148:149], v[148:149], v[100:101]
    v_pk_add_f32 v[150:151], v[150:151], v[102:103]
    v_pk_add_f32 v[152:153], v[152:153], v[104:105]
    v_pk_add_f32 v[154:155], v[154:155], v[106:107]
    v_pk_add_f32 v[156:157], v[156:157], v[108:109]
    v_pk_add_f32 v[158:159], v[158:159], v[110:111]
    v_pk_mul_f32 v[4:5], v[144:145], 0
    v_pk_fma_f32 v[4:5], v[146:147], 0, v[4:5]
    v_pk_fma_f32 v[4:5], v[148:149], 0, v[4:5]
    v_pk_fma_f32 v[4:5], v[150:151], 0, v[4:5]
    v_pk_fma_f32 v[4:5], v[152:153], 0, v[4:5]
    v_pk_fma_f32 v[4:5], v[154:155], 0, v[4:5]
    v_pk_fma_f32 v[4:5], v[156:157], 0, v[4:5]
    v_pk_fma_f32 v[4:5], v[158:159], 0, v[4:5]
    v_cmp_nle_f32 s[72:73], s12, v156
    v_cmp_nge_f32 s[74:75], s13, v156
    v_cmp_u_f32 vcc, v4, v5
    s_nop 0
    s_or_b32 s73, s73, s75
    s_or_b32 s73, s73, vcc_hi
    s_or_b32 s73, s73, vcc_lo
    s_cmp_lg_u32 s73, 0
    s_cbranch_scc1 L_fb
L_fin:
    v_rcp_f32 v4, v156
    s_nop 0
    v_mul_f32 v4, v4, v15
    v_mov_b32 v5, v4
    s_nop 1
    v_permlane32_swap_b32 v5, v4
    v_pk_mul_f32 v[150:151], v[150:151], v[4:5] op_sel_hi:[1,0]
    v_pk_mul_f32 v[154:155], v[154:155], v[4:5] op_sel_hi:[1,0]
    v_pk_mul_f32 v[158:159], v[158:159], v[4:5] op_sel_hi:[1,0]
    v_pk_mul_f32 v[156:157], v[156:157], v[4:5] op_sel_hi:[1,0]
    v_pk_mul_f32 v[144:145], v[144:145], v[4:5] op_sel_hi:[1,0]
    v_pk_mul_f32 v[146:147], v[146:147], v[4:5] op_sel_hi:[1,0]
    v_pk_mul_f32 v[148:149], v[148:149], v[4:5] op_sel_hi:[1,0]
    v_pk_mul_f32 v[152:153], v[152:153], v[4:5] op_sel_hi:[1,0]
    v_cvt_pk_bf16_f32 v35, v150, v151
    v_cvt_pk_bf16_f32 v39, v158, v159
    v_perm_b32 v44, v39, v35, s11
    v_cvt_pk_bf16_f32 v38, v156, v157
    v_mov_b32 v45, v44
    v_cvt_pk_bf16_f32 v32, v144, v145
    v_cvt_pk_bf16_f32 v33, v146, v147
    v_permlane32_swap_b32 v45, v44
    v_cvt_pk_bf16_f32 v34, v148, v149
    v_cvt_pk_bf16_f32 v36, v152, v153
    v_cvt_pk_bf16_f32 v37, v154, v155
    v_cndmask_b32 v38, v38, v45, s[14:15]
    v_cndmask_b32 v39, v39, v45, s[14:15]
    v_perm_b32 v38, v35, v38, v41
    v_perm_b32 v35, v40, v35, s10
    v_perm_b32 v39, v40, v39, v42
    buffer_store_dwordx4 v[32:35], v2, s[56:59], s6 offen
    buffer_store_dwordx4 v[36:39], v2, s[56:59], s6 offen offset:1024
    s_add_u32 s6, s6, 0x700000
    s_add_u32 s7, s7, 0x70000
    s_waitcnt vmcnt(0)
    buffer_store_dwordx4 v[32:35], v2, s[56:59], s6 offen sc1
    buffer_store_dwordx4 v[36:39], v2, s[56:59], s6 offen offset:1024 sc1
    v_mov_b32 v7, s4
    s_mov_b32 exec_lo, 1
    s_mov_b32 exec_hi, 0
    buffer_store_dword v7, off, s[56:59], s7 sc1
    s_mov_b64 exec, -1
    s_endpgm
L_fb:
    s_add_u32 s76, s48, 0x100000
    s_addc_u32 s77, s49, 0
    s_mov_b32 s78, 0x40000
    s_mov_b32 s79, 0x20000
    v_mov_b32 v7, 0xff800000
    s_mov_b32 s12, 0
L_fb1:
    buffer_load_dwordx4 v[192:195], v2, s[76:79], s12 offen sc1
    buffer_load_dwordx4 v[196:199], v2, s[76:79], s12 offen offset:1024 sc1
    s_waitcnt vmcnt(0)
    v_mfma_f32_32x32x16_bf16 v[160:175], v[192:195], v[88:91], 0
    v_mfma_f32_32x32x16_bf16 v[160:175], v[196:199], v[92:95], v[160:175]
    s_nop 11
    v_max3_f32 v7, v7, v160, v161
    v_max3_f32 v7, v7, v162, v163
    v_max3_f32 v7, v7, v164, v165
    v_max3_f32 v7, v7, v166, v167
    v_max3_f32 v7, v7, v168, v169
    v_max3_f32 v7, v7, v170, v171
    v_max3_f32 v7, v7, v172, v173
    v_max3_f32 v7, v7, v174, v175
    s_add_u32 s12, s12, 4096
    s_cmp_lt_u32 s12, 262144
    s_cbranch_scc1 L_fb1
    v_mov_b32 v8, v7
    s_nop 1
    v_permlane32_swap_b32 v8, v7
    v_max_f32 v7, v7, v8
    v_mov_b32 v144, 0
    v_mov_b32 v145, 0
    v_mov_b32 v146, 0
    v_mov_b32 v147, 0
    v_mov_b32 v148, 0
    v_mov_b32 v149, 0
    v_mov_b32 v150, 0
    v_mov_b32 v151, 0
    v_mov_b32 v152, 0
    v_mov_b32 v153, 0
    v_mov_b32 v154, 0
    v_mov_b32 v155, 0
    v_mov_b32 v156, 0
    v_mov_b32 v157, 0
    v_mov_b32 v158, 0
    v_mov_b32 v159, 0
    s_mov_b32 s12, 0
L_fb2:
    buffer_load_dwordx4 v[192:195], v2, s[76:79], s12 offen offset:0 sc1
    buffer_load_dwordx4 v[196:199], v2, s[76:79], s12 offen offset:1024 sc1
    buffer_load_dwordx4 v[200:203], v2, s[76:79], s12 offen offset:2048 sc1
    buffer_load_dwordx4 v[204:207], v2, s[76:79], s12 offen offset:3072 sc1
    s_waitcnt vmcnt(0)
    v_mfma_f32_32x32x16_bf16 v[160:175], v[192:195], v[88:91], 0
    v_mfma_f32_32x32x16_bf16 v[160:175], v[196:199], v[92:95], v[160:175]
    s_nop 11
    v_sub_f32 v160, v160, v7
    v_sub_f32 v161, v161, v7
    v_sub_f32 v162, v162, v7
    v_sub_f32 v163, v163, v7
    v_sub_f32 v164, v164, v7
    v_sub_f32 v165, v165, v7
    v_sub_f32 v166, v166, v7
    v_sub_f32 v167, v167, v7
    v_sub_f32 v168, v168, v7
    v_sub_f32 v169, v169, v7
    v_sub_f32 v170, v170, v7
    v_sub_f32 v171, v171, v7
    v_sub_f32 v172, v172, v7
    v_sub_f32 v173, v173, v7
    v_sub_f32 v174, v174, v7
    v_sub_f32 v175, v175, v7
    v_exp_f32 v160, v160
    v_exp_f32 v161, v161
    v_exp_f32 v162, v162
    v_exp_f32 v163, v163
    v_exp_f32 v164, v164
    v_exp_f32 v165, v165
    v_exp_f32 v166, v166
    v_exp_f32 v167, v167
    v_exp_f32 v168, v168
    v_exp_f32 v169, v169
    v_exp_f32 v170, v170
    v_exp_f32 v171, v171
    v_exp_f32 v172, v172
    v_exp_f32 v173, v173
    v_exp_f32 v174, v174
    v_exp_f32 v175, v175
    v_cvt_pk_bf16_f32 v16, v160, v161
    v_cvt_pk_bf16_f32 v17, v162, v163
    v_cvt_pk_bf16_f32 v18, v164, v165
    v_cvt_pk_bf16_f32 v19, v166, v167
    v_cvt_pk_bf16_f32 v20, v168, v169
    v_cvt_pk_bf16_f32 v21, v170, v171
    v_cvt_pk_bf16_f32 v22, v172, v173
    v_cvt_pk_bf16_f32 v23, v174, v175
    v_mfma_f32_32x32x16_bf16 v[144:159], v[200:203], v[16:19], v[144:159]
    s_nop 0
    v_mfma_f32_32x32x16_bf16 v[144:159], v[204:207], v[20:23], v[144:159]
    s_add_u32 s12, s12, 4096
    s_cmp_lt_u32 s12, 262144
    s_cbranch_scc1 L_fb2
    s_nop 8
    s_branch L_fin
.section .rodata,"a"
.p2align 6
.amdhsa_kernel gated_mix__grouped_kv_mqa__ssm_conv_s4__prompt_kernel
  .amdhsa_next_free_vgpr 256
  .amdhsa_next_free_sgpr 102
  .amdhsa_accum_offset 256
  .amdhsa_group_segment_fixed_size 0
  .amdhsa_kernarg_size 144
  .amdhsa_user_sgpr_count 2
  .amdhsa_user_sgpr_kernarg_segment_ptr 1
  .amdhsa_system_sgpr_workgroup_id_x 1
.end_amdhsa_kernel
```
